```python
import torch

def _softmax(x, axis=-1):
    return torch.softmax(x, dim=axis)
def _gelu(x):
    return torch.nn.functional.gelu(x, approximate="tanh")
def _silu(x):
    return torch.nn.functional.silu(x)
def _sigmoid(x):
    return torch.sigmoid(x)
def _layernorm(x, axis=-1, eps=1e-5):
    m = x.mean(dim=axis, keepdim=True)
    v = x.var(dim=axis, keepdim=True, unbiased=False)
    return (x - m) / torch.sqrt(v + eps)
def _scatter_add(tgt, idx, src, axis=0):
    return tgt.clone().index_add_(axis, idx, src)
def _segment_sum(src, seg, n):
    out = torch.zeros((n,) + src.shape[1:], dtype=src.dtype)
    return out.index_add_(0, seg, src)
def _pad(x, pw):
    flat = tuple(v for pair in reversed(pw) for v in pair)
    return torch.nn.functional.pad(x, flat)

kernel_name = 'recurrent_scan__sliding_block_cached__glu_gated_reglu__decode'

def setup_inputs():

    _w = (lambda a: (lambda t: t.to(torch.bfloat16) if t.is_floating_point() else t)(torch.as_tensor(a)))
    def _A_setup():
        B, Sq, D = 4, 1, 448
        Hq, Hkv, Sk, Dh = 16, 8, 8192, 256
        assert Hq % Hkv == 0, (Hq, Hkv)
        return {
            "x": _w((lambda *s: torch.randn(*s, dtype=torch.bfloat16) * 0.05)(B, Sq, D)),
            "k_cache": _w((lambda *s: torch.randn(*s, dtype=torch.bfloat16) * 3.2)(B, Hkv, Sk, Dh)),
            "v_cache": _w((lambda *s: torch.randn(*s, dtype=torch.bfloat16) * 3.2)(B, Hkv, Sk, Dh)),
            "wq": _w((lambda *s: torch.randn(*s, dtype=torch.bfloat16) * 3.2)(D, Hq * Dh) * (D ** -0.5)),
            "wo": _w((lambda *s: torch.randn(*s, dtype=torch.bfloat16) * 3.2)(Hq * Dh, D) * ((Hq * Dh) ** -0.5)),
        }
    _A_in = _A_setup()

    def _B_setup():
        B, S, D, F = 4, 1, 448, 1792
        return {
            "x": _w((lambda *s: torch.randn(*s, dtype=torch.bfloat16) * 0.05)(B, S, D)),
            "W_gate": _w((lambda *s: torch.randn(*s, dtype=torch.bfloat16) * 0.4)(D, F) * (2.0 / D) ** 0.5),
            "W_up": _w((lambda *s: torch.randn(*s, dtype=torch.bfloat16) * 0.4)(D, F) * (2.0 / D) ** 0.5),
            "W_down": _w((lambda *s: torch.randn(*s, dtype=torch.bfloat16) * 0.4)(F, D) * (1.0 / F) ** 0.5),
        }
    _B_in = _B_setup()

    return {
        "A_x": _A_in["x"],
        "A_k_cache": _A_in["k_cache"],
        "A_v_cache": _A_in["v_cache"],
        "A_wq": _A_in["wq"],
        "A_wo": _A_in["wo"],
        "B_x": _B_in["x"],
        "B_W_gate": _B_in["W_gate"],
        "B_W_up": _B_in["W_up"],
        "B_W_down": _B_in["W_down"],
    }

def reference(A_x, A_k_cache, A_v_cache, A_wq, A_wo, B_x, B_W_gate, B_W_up, B_W_down):
    def _A_ref(x, k_cache, v_cache, wq, wo):
        B, Sq, D = x.shape
        Hq, Dh = 16, 256
        Hkv, Sk = k_cache.shape[1], k_cache.shape[2]
        W = min(4096, max(256, Sk // 4))
        rep = Hq // Hkv
        q = (lambda x, *d: x.permute(*d))((x @ wq).reshape(B, Sq, Hq, Dh), 0, 2, 1, 3)
        k = (lambda x, n, axis: torch.repeat_interleave(x, n, dim=axis))(k_cache[:, :, Sk - W:, :], rep, axis=1)
        v = (lambda x, n, axis: torch.repeat_interleave(x, n, dim=axis))(v_cache[:, :, Sk - W:, :], rep, axis=1)
        scores = torch.einsum("bhqd,bhkd->bhqk", q, k) * (Dh ** -0.5)
        p = _softmax(scores, axis=-1)
        o = torch.einsum("bhqk,bhkd->bhqd", p, v)
        return (lambda x, *d: x.permute(*d))(o, 0, 2, 1, 3).reshape(B, Sq, Hq * Dh) @ wo

    def _B_ref(x, W_gate, W_up, W_down):
        gate = torch.einsum("bsd,df->bsf", x, W_gate)
        up = torch.einsum("bsd,df->bsf", x, W_up)
        gate = gate * (lambda x, dt: x.to(dt))(gate > 0, gate.dtype)
        h = gate * up
        return torch.einsum("bsf,fd->bsd", h, W_down)

    x = A_x
    xn = _layernorm(x, axis=-1)
    s = _A_ref(xn, A_k_cache, A_v_cache, A_wq, A_wo)
    g = _silu(_B_ref(xn, B_W_gate, B_W_up, B_W_down))
    return x + s * g
```

```asm
; @launch grid=(256,1,1) block=(512,1,1) lds=159488
.amdgcn_target "amdgcn-amd-amdhsa--gfx950"
.text
.globl recurrent_scan__sliding_block_cached__glu_gated_reglu__decode_kernel
.p2align 8
.type recurrent_scan__sliding_block_cached__glu_gated_reglu__decode_kernel,@function
recurrent_scan__sliding_block_cached__glu_gated_reglu__decode_kernel:
    s_cmp_ge_u32 s2, 256
    s_cbranch_scc1 L_end
    s_load_dwordx16 s[4:19], s[0:1], 0
    s_load_dwordx8 s[20:27], s[0:1], 64
    s_getpc_b64 s[52:53]
    s_lshr_b32 s54, s2, 3
    s_and_b32 s54, s54, 3
    s_lshl_b32 s54, s54, 12
    v_lshlrev_b32 v2, 3, v0
    v_add_u32 v2, s54, v2
    global_load_dwordx2 v[236:237], v2, s[52:53]
    v_and_b32 v1, 63, v0
    v_lshrrev_b32 v2, 6, v0
    v_mov_b32 v12, 131072
    v_readfirstlane_b32 s3, v2
    v_mov_b32 v14, 1
    s_and_b32 s28, s2, 7
    s_lshr_b32 s29, s2, 3
    s_and_b32 s30, s29, 7
    s_lshr_b32 s31, s29, 3
    s_lshl_b32 s32, s31, 3
    s_add_u32 s32, s32, s28
    s_and_b32 s63, s29, 3
    s_bfe_u32 s52, s29, 0x10002
    s_lshl_b32 s53, s28, 1
    s_add_u32 s53, s53, s52
    s_add_u32 s54, s28, 6
    s_cmp_lt_u32 s28, 6
    s_cselect_b32 s53, s53, s54
    s_cselect_b32 s55, 0, s52
    s_lshl_b32 s53, s53, 8
    s_bfe_u32 s54, s29, 0x10003
    s_add_u32 s98, s54, 1
    s_cmp_lg_u32 s55, 0
    s_cselect_b32 s98, 3, s98
    s_lshl_b32 s33, s28, 10
    s_lshr_b32 s54, s29, 2
    s_lshl_b32 s54, s54, 8
    s_add_u32 s33, s33, s54
    s_cmp_lt_u32 s29, 16
    s_cselect_b32 s33, s33, s53
    s_cselect_b32 s98, 0, s98
    s_mov_b32 s62, 3584
    s_cselect_b32 s62, 8192, s62

    s_cmp_lt_u32 s3, 4
    s_cbranch_scc1 L_cw
    s_setprio 3
    s_sub_u32 s35, s3, 4
    v_lshrrev_b32 v2, 4, v1
    v_and_b32 v3, 15, v1
    v_mul_lo_u32 v5, v2, s62
    v_lshl_add_u32 v5, v3, 4, v5
    s_mul_i32 s48, s63, 112
    s_lshl_b32 s52, s35, 2
    s_add_u32 s48, s48, s52
    s_mul_i32 s48, s48, s62
    s_add_u32 s48, s48, s33
    s_cmp_eq_u32 s98, 3
    s_cselect_b32 s48, 0x7ffffff0, s48
    s_cselect_b32 s49, 0, s62
    s_lshl_b32 s49, s49, 4
    s_lshl_b32 s34, s29, 12
    s_lshl_b32 s52, s35, 10
    s_add_u32 s34, s34, s52
    v_mul_u32_u24 v6, 896, v2
    v_lshl_add_u32 v6, v3, 4, v6
    s_and_b32 s53, s29, 3
    s_cmp_eq_u32 s53, 3
    s_cselect_b32 s54, 8, 16
    v_cmp_le_u32 vcc, s54, v3
    v_mov_b32 v7, 0x7ffffff0
    s_lshl_b32 s52, s28, 3
    s_lshl_b32 s55, s28, 2
    s_add_u32 s55, s55, 24
    s_cmp_lt_u32 s28, 6
    s_cselect_b32 s52, s52, s55
    s_cselect_b32 s58, 32, 16
    v_cndmask_b32 v6, v6, v7, vcc
    s_lshr_b32 s55, s29, 2
    s_add_u32 s52, s52, s55
    s_mul_i32 s50, s52, 28672
    s_lshl_b32 s56, s53, 8
    s_add_u32 s50, s50, s56
    s_mul_i32 s56, s35, 3584
    s_add_u32 s50, s50, s56
    s_cmp_ge_u32 s29, s58
    s_cselect_b32 s50, 0x7ffffff0, s50
    s_lshl_b32 s51, s35, 10
    s_add_u32 s51, s51, 143104
    s_lshl_b32 s33, s32, 22
    s_lshl_b32 s52, s30, 17
    s_add_u32 s33, s33, s52
    s_add_u32 s33, s33, 3145728
    v_lshrrev_b32 v3, 5, v1
    s_and_b32 s52, s35, 1
    s_lshl_b32 s52, s52, 1
    v_add_u32 v4, s52, v3
    v_and_b32 v7, 31, v1
    v_xor_b32 v7, v7, v4
    v_lshlrev_b32 v7, 4, v7
    v_lshl_add_u32 v2, v3, 9, v7
    s_add_u32 s52, s34, 102400
    s_waitcnt lgkmcnt(0)
    s_cmp_eq_u32 s98, 0
    s_cselect_b32 s40, s10, s16
    s_cselect_b32 s41, s11, s17
    s_mov_b32 s42, 1605632
    s_cselect_b32 s42, 3670016, s42
    s_cmp_eq_u32 s98, 2
    s_cselect_b32 s40, s18, s40
    s_cselect_b32 s41, s19, s41
    s_mov_b32 s43, 0x20000
    s_and_b32 s52, s52, 0x1ffff
    s_mov_b32 m0, s52
    s_add_u32 s52, s52, 4096
    buffer_load_dwordx4 v5, s[40:43], s48 offen nt lds
    s_add_u32 s48, s48, s49
    s_and_b32 s52, s52, 0x1ffff
    s_mov_b32 m0, s52
    s_add_u32 s52, s52, 4096
    buffer_load_dwordx4 v5, s[40:43], s48 offen nt lds
    s_add_u32 s48, s48, s49
    s_and_b32 s52, s52, 0x1ffff
    s_mov_b32 m0, s52
    s_add_u32 s52, s52, 4096
    buffer_load_dwordx4 v5, s[40:43], s48 offen nt lds
    s_add_u32 s48, s48, s49
    s_and_b32 s52, s52, 0x1ffff
    s_mov_b32 m0, s52
    s_add_u32 s52, s52, 4096
    buffer_load_dwordx4 v5, s[40:43], s48 offen nt lds
    s_add_u32 s48, s48, s49
    s_and_b32 s52, s52, 0x1ffff
    s_mov_b32 m0, s52
    s_add_u32 s52, s52, 4096
    buffer_load_dwordx4 v5, s[40:43], s48 offen nt lds
    s_add_u32 s48, s48, s49
    s_and_b32 s52, s52, 0x1ffff
    s_mov_b32 m0, s52
    s_add_u32 s52, s52, 4096
    buffer_load_dwordx4 v5, s[40:43], s48 offen nt lds
    s_add_u32 s48, s48, s49
    s_and_b32 s52, s52, 0x1ffff
    s_mov_b32 m0, s52
    s_add_u32 s52, s52, 4096
    buffer_load_dwordx4 v5, s[40:43], s48 offen nt lds
    s_add_u32 s48, s48, s49
    s_mov_b32 s44, s20
    s_mov_b32 s45, s21
    s_mov_b32 s46, 1605632
    s_mov_b32 s47, 0x20000
    s_mov_b32 m0, s51
    s_add_u32 s51, s51, 4096
    buffer_load_dwordx4 v6, s[44:47], s50 offen nt lds
    s_mov_b32 m0, s51
    s_add_u32 s50, s50, 14336
    buffer_load_dwordx4 v6, s[44:47], s50 offen nt lds
    s_mov_b32 s40, s6
    s_mov_b32 s41, s7
    s_mov_b32 s42, 0x8000000
    s_mov_b32 s43, 0x20000
    s_mov_b32 s52, s34
    s_mov_b32 s54, 5
L_k_1:
    s_and_b32 s52, s52, 0x1ffff
    s_lshr_b32 s55, s52, 7
    s_and_b32 s55, s55, 0xc0
    v_xor_b32 v3, s55, v2
    s_mov_b32 m0, s52
    s_add_u32 s56, s52, s33
    buffer_load_dwordx4 v3, s[40:43], s56 offen nt lds
    s_add_u32 s52, s52, 4096
    s_sub_u32 s54, s54, 1
    s_cmp_lg_u32 s54, 0
    s_cbranch_scc1 L_k_1
    s_mov_b32 s36, s26
    s_mov_b32 s37, s27
    s_mov_b32 s38, 4456448
    s_mov_b32 s39, 0x20000
    s_barrier
    s_waitcnt vmcnt(7)
    s_mov_b64 exec, 1
    ds_add_u32 v12, v14 offset:24
    s_mov_b64 exec, -1
    s_mov_b32 s54, 15
L_k_2:
    s_and_b32 s52, s52, 0x1ffff
    s_lshr_b32 s55, s52, 7
    s_and_b32 s55, s55, 0xc0
    v_xor_b32 v3, s55, v2
    s_mov_b32 m0, s52
    s_add_u32 s56, s52, s33
    s_waitcnt vmcnt(5)
    buffer_load_dwordx4 v3, s[40:43], s56 offen nt lds
    s_add_u32 s52, s52, 4096
    s_sub_u32 s54, s54, 1
    s_cmp_lg_u32 s54, 0
    s_cbranch_scc1 L_k_2
    s_mov_b64 exec, 1
    ds_add_u32 v12, v14 offset:48
    s_mov_b64 exec, -1
    s_mov_b32 s54, 5
L_k_3:
    s_and_b32 s52, s52, 0x1ffff
    s_lshr_b32 s55, s52, 7
    s_and_b32 s55, s55, 0xc0
    v_xor_b32 v3, s55, v2
    s_mov_b32 m0, s52
    s_add_u32 s56, s52, s33
    s_waitcnt vmcnt(5)
    buffer_load_dwordx4 v3, s[40:43], s56 offen nt lds
    s_add_u32 s52, s52, 4096
    s_sub_u32 s54, s54, 1
    s_cmp_lg_u32 s54, 0
    s_cbranch_scc1 L_k_3
    s_mov_b32 s59, 0
L_wf_4:
    ds_read_b32 v13, v12 offset:40
    s_waitcnt lgkmcnt(0)
    v_readfirstlane_b32 s58, v13
    s_cmp_ge_u32 s58, 4
    s_cbranch_scc1 L_wfd_5
    s_sleep 1
    s_add_u32 s59, s59, 1
    s_cmp_lt_u32 s59, 65536
    s_cbranch_scc1 L_wf_4
    s_mov_b32 s57, 30
    s_branch L_abort
L_wfd_5:
    s_mov_b32 s54, 7
L_k_6:
    s_and_b32 s52, s52, 0x1ffff
    s_lshr_b32 s55, s52, 7
    s_and_b32 s55, s55, 0xc0
    v_xor_b32 v3, s55, v2
    s_mov_b32 m0, s52
    s_add_u32 s56, s52, s33
    s_waitcnt vmcnt(5)
    buffer_load_dwordx4 v3, s[40:43], s56 offen nt lds
    s_add_u32 s52, s52, 4096
    s_sub_u32 s54, s54, 1
    s_cmp_lg_u32 s54, 0
    s_cbranch_scc1 L_k_6
    s_mov_b32 s44, s8
    s_mov_b32 s45, s9
    s_mov_b32 s46, 0x8000000
    s_mov_b32 s47, 0x20000
    v_lshrrev_b32 v3, 4, v1
    v_and_b32 v4, 15, v1
    v_lshlrev_b32 v4, 4, v4
    v_lshl_add_u32 v6, v3, 9, v4
    s_and_b32 s52, s29, 15
    s_lshl_b32 s52, s52, 13
    s_lshl_b32 s53, s35, 11
    s_add_u32 s52, s52, s53
    s_and_b32 s52, s52, 0x1ffff
    s_add_u32 s56, s52, s33
    s_waitcnt vmcnt(5)
    buffer_load_dwordx4 v[64:67], v6, s[44:47], s56 offen offset:0 nt
    s_waitcnt vmcnt(5)
    buffer_load_dwordx4 v[68:71], v6, s[44:47], s56 offen offset:256 nt
    s_add_u32 s52, s52, 8192
    s_and_b32 s52, s52, 0x1ffff
    s_add_u32 s56, s52, s33
    s_waitcnt vmcnt(5)
    buffer_load_dwordx4 v[72:75], v6, s[44:47], s56 offen offset:0 nt
    s_waitcnt vmcnt(5)
    buffer_load_dwordx4 v[76:79], v6, s[44:47], s56 offen offset:256 nt
    s_add_u32 s52, s52, 8192
    s_and_b32 s52, s52, 0x1ffff
    s_add_u32 s56, s52, s33
    s_waitcnt vmcnt(5)
    buffer_load_dwordx4 v[80:83], v6, s[44:47], s56 offen offset:0 nt
    s_waitcnt vmcnt(5)
    s_mov_b64 exec, 1
    ds_add_u32 v12, v14 offset:0
    s_mov_b64 exec, -1
    buffer_load_dwordx4 v[84:87], v6, s[44:47], s56 offen offset:256 nt
    s_add_u32 s52, s52, 8192
    s_and_b32 s52, s52, 0x1ffff
    s_add_u32 s56, s52, s33
    s_waitcnt vmcnt(5)
    buffer_load_dwordx4 v[88:91], v6, s[44:47], s56 offen offset:0 nt
    s_waitcnt vmcnt(5)
    buffer_load_dwordx4 v[92:95], v6, s[44:47], s56 offen offset:256 nt
    s_add_u32 s52, s52, 8192
    s_and_b32 s52, s52, 0x1ffff
    s_add_u32 s56, s52, s33
    s_waitcnt vmcnt(5)
    buffer_load_dwordx4 v[96:99], v6, s[44:47], s56 offen offset:0 nt
    s_waitcnt vmcnt(5)
    buffer_load_dwordx4 v[100:103], v6, s[44:47], s56 offen offset:256 nt
    s_add_u32 s52, s52, 8192
    s_and_b32 s52, s52, 0x1ffff
    s_add_u32 s56, s52, s33
    s_waitcnt vmcnt(5)
    buffer_load_dwordx4 v[104:107], v6, s[44:47], s56 offen offset:0 nt
    s_waitcnt vmcnt(5)
    buffer_load_dwordx4 v[108:111], v6, s[44:47], s56 offen offset:256 nt
    s_add_u32 s52, s52, 8192
    s_and_b32 s52, s52, 0x1ffff
    s_add_u32 s56, s52, s33
    s_waitcnt vmcnt(5)
    buffer_load_dwordx4 v[112:115], v6, s[44:47], s56 offen offset:0 nt
    s_waitcnt vmcnt(5)
    buffer_load_dwordx4 v[116:119], v6, s[44:47], s56 offen offset:256 nt
    s_add_u32 s52, s52, 8192
    s_and_b32 s52, s52, 0x1ffff
    s_add_u32 s56, s52, s33
    s_waitcnt vmcnt(5)
    buffer_load_dwordx4 v[120:123], v6, s[44:47], s56 offen offset:0 nt
    s_waitcnt vmcnt(5)
    buffer_load_dwordx4 v[124:127], v6, s[44:47], s56 offen offset:256 nt
    s_add_u32 s52, s52, 8192
    s_and_b32 s52, s52, 0x1ffff
    s_add_u32 s56, s52, s33
    s_waitcnt vmcnt(5)
    buffer_load_dwordx4 v[128:131], v6, s[44:47], s56 offen offset:0 nt
    s_waitcnt vmcnt(5)
    buffer_load_dwordx4 v[132:135], v6, s[44:47], s56 offen offset:256 nt
    s_add_u32 s52, s52, 8192
    s_and_b32 s52, s52, 0x1ffff
    s_add_u32 s56, s52, s33
    s_waitcnt vmcnt(5)
    buffer_load_dwordx4 v[136:139], v6, s[44:47], s56 offen offset:0 nt
    s_waitcnt vmcnt(5)
    buffer_load_dwordx4 v[140:143], v6, s[44:47], s56 offen offset:256 nt
    s_add_u32 s52, s52, 8192
    s_and_b32 s52, s52, 0x1ffff
    s_add_u32 s56, s52, s33
    s_waitcnt vmcnt(5)
    buffer_load_dwordx4 v[144:147], v6, s[44:47], s56 offen offset:0 nt
    s_waitcnt vmcnt(5)
    buffer_load_dwordx4 v[148:151], v6, s[44:47], s56 offen offset:256 nt
    s_add_u32 s52, s52, 8192
    s_and_b32 s52, s52, 0x1ffff
    s_add_u32 s56, s52, s33
    s_waitcnt vmcnt(5)
    buffer_load_dwordx4 v[152:155], v6, s[44:47], s56 offen offset:0 nt
    s_waitcnt vmcnt(5)
    buffer_load_dwordx4 v[156:159], v6, s[44:47], s56 offen offset:256 nt
    s_add_u32 s52, s52, 8192
    s_and_b32 s52, s52, 0x1ffff
    s_add_u32 s56, s52, s33
    s_waitcnt vmcnt(5)
    buffer_load_dwordx4 v[160:163], v6, s[44:47], s56 offen offset:0 nt
    s_waitcnt vmcnt(5)
    buffer_load_dwordx4 v[164:167], v6, s[44:47], s56 offen offset:256 nt
    s_add_u32 s52, s52, 8192
    s_and_b32 s52, s52, 0x1ffff
    s_add_u32 s56, s52, s33
    s_waitcnt vmcnt(5)
    buffer_load_dwordx4 v[168:171], v6, s[44:47], s56 offen offset:0 nt
    s_waitcnt vmcnt(5)
    buffer_load_dwordx4 v[172:175], v6, s[44:47], s56 offen offset:256 nt
    s_add_u32 s52, s52, 8192
    s_and_b32 s52, s52, 0x1ffff
    s_add_u32 s56, s52, s33
    s_waitcnt vmcnt(5)
    buffer_load_dwordx4 v[176:179], v6, s[44:47], s56 offen offset:0 nt
    s_waitcnt vmcnt(5)
    buffer_load_dwordx4 v[180:183], v6, s[44:47], s56 offen offset:256 nt
    s_add_u32 s52, s52, 8192
    s_and_b32 s52, s52, 0x1ffff
    s_add_u32 s56, s52, s33
    s_waitcnt vmcnt(5)
    buffer_load_dwordx4 v[184:187], v6, s[44:47], s56 offen offset:0 nt
    s_waitcnt vmcnt(5)
    buffer_load_dwordx4 v[188:191], v6, s[44:47], s56 offen offset:256 nt
    v_and_b32 v2, 1, v1
    v_lshlrev_b32 v2, 4, v2
    v_mov_b32 v3, 0xffff
    v_lshlrev_b32 v2, v2, v3
    v_bfe_u32 v3, v1, 1, 2
    v_cmp_eq_u32 vcc, 0, v3
    v_cmp_eq_u32 s[64:65], 1, v3
    v_cmp_eq_u32 s[66:67], 2, v3
    v_cmp_eq_u32 s[56:57], 3, v3
    s_nop 1
    v_cndmask_b32 v8, 0, v2, vcc
    v_cndmask_b32 v9, 0, v2, s[64:65]
    v_cndmask_b32 v10, 0, v2, s[66:67]
    v_cndmask_b32 v11, 0, v2, s[56:57]
    v_bfe_u32 v2, v1, 3, 1
    v_lshlrev_b32 v2, 8, v2
    v_lshrrev_b32 v3, 4, v1
    v_lshl_add_u32 v2, v3, 6, v2
    s_lshl_b32 s52, s35, 9
    s_add_u32 s52, s52, 132352
    v_add_u32 v2, s52, v2
    v_lshlrev_b32 v48, 4, v1
    s_lshl_b32 s52, s35, 11
    s_add_u32 s52, s52, 143104
    v_add_u32 v49, s52, v48
    v_add_u32 v48, 143104, v48
    v_bfe_u32 v5, v1, 2, 2
    v_mul_u32_u24 v5, 4096, v5
    v_lshrrev_b32 v6, 5, v1
    v_lshl_add_u32 v5, v6, 7, v5
    v_and_b32 v6, 3, v1
    v_lshl_add_u32 v5, v6, 5, v5
    v_bfe_u32 v6, v1, 4, 1
    v_lshl_add_u32 v51, v6, 4, v5
    s_mul_i32 s44, s32, 32768
    s_mul_i32 s45, s30, 512
    s_add_u32 s44, s44, s45
    s_add_u32 s44, s44, 1179648
    s_add_u32 s45, s44, 16384
    s_barrier
    ds_read_b128 v[16:19], v2 offset:0
    ds_read_b128 v[20:23], v2 offset:16
    ds_read_b128 v[24:27], v2 offset:32
    ds_read_b128 v[28:31], v2 offset:48
    ds_read_b64 v[4:5], v12 offset:32
    ds_read_b32 v6, v12 offset:56
    s_waitcnt lgkmcnt(0)
    v_readfirstlane_b32 s97, v6
    v_mov_b32 v198, v4
    v_mov_b32 v199, v5
    v_mov_b32 v202, v4
    v_mov_b32 v203, v5
    v_mov_b32 v206, v4
    v_mov_b32 v207, v5
    v_mov_b32 v210, v4
    v_mov_b32 v211, v5
    v_readfirstlane_b32 s60, v4
    v_readfirstlane_b32 s61, v5
    v_and_b32 v32, v16, v8
    v_and_b32 v33, v16, v9
    v_and_b32 v34, v16, v10
    v_and_b32 v35, v16, v11
    v_and_b32 v36, v17, v8
    v_and_b32 v37, v17, v9
    v_and_b32 v38, v17, v10
    v_and_b32 v39, v17, v11
    s_waitcnt vmcnt(30)
    v_mfma_f32_16x16x32_bf16 v[40:43], v[32:35], v[64:67], 0
    v_mfma_f32_16x16x32_bf16 v[44:47], v[32:35], v[68:71], 0
    v_and_b32 v32, v18, v8
    v_and_b32 v33, v18, v9
    v_and_b32 v34, v18, v10
    v_and_b32 v35, v18, v11
    s_waitcnt vmcnt(28)
    v_mfma_f32_16x16x32_bf16 v[40:43], v[36:39], v[72:75], v[40:43]
    v_mfma_f32_16x16x32_bf16 v[44:47], v[36:39], v[76:79], v[44:47]
    v_and_b32 v36, v19, v8
    v_and_b32 v37, v19, v9
    v_and_b32 v38, v19, v10
    v_and_b32 v39, v19, v11
    s_waitcnt vmcnt(26)
    v_mfma_f32_16x16x32_bf16 v[40:43], v[32:35], v[80:83], v[40:43]
    v_mfma_f32_16x16x32_bf16 v[44:47], v[32:35], v[84:87], v[44:47]
    v_and_b32 v32, v20, v8
    v_and_b32 v33, v20, v9
    v_and_b32 v34, v20, v10
    v_and_b32 v35, v20, v11
    s_waitcnt vmcnt(24)
    v_mfma_f32_16x16x32_bf16 v[40:43], v[36:39], v[88:91], v[40:43]
    v_mfma_f32_16x16x32_bf16 v[44:47], v[36:39], v[92:95], v[44:47]
    v_and_b32 v36, v21, v8
    v_and_b32 v37, v21, v9
    v_and_b32 v38, v21, v10
    v_and_b32 v39, v21, v11
    s_waitcnt vmcnt(22)
    v_mfma_f32_16x16x32_bf16 v[40:43], v[32:35], v[96:99], v[40:43]
    v_mfma_f32_16x16x32_bf16 v[44:47], v[32:35], v[100:103], v[44:47]
    v_and_b32 v32, v22, v8
    v_and_b32 v33, v22, v9
    v_and_b32 v34, v22, v10
    v_and_b32 v35, v22, v11
    s_waitcnt vmcnt(20)
    v_mfma_f32_16x16x32_bf16 v[40:43], v[36:39], v[104:107], v[40:43]
    v_mfma_f32_16x16x32_bf16 v[44:47], v[36:39], v[108:111], v[44:47]
    v_and_b32 v36, v23, v8
    v_and_b32 v37, v23, v9
    v_and_b32 v38, v23, v10
    v_and_b32 v39, v23, v11
    s_waitcnt vmcnt(18)
    v_mfma_f32_16x16x32_bf16 v[40:43], v[32:35], v[112:115], v[40:43]
    v_mfma_f32_16x16x32_bf16 v[44:47], v[32:35], v[116:119], v[44:47]
    v_and_b32 v32, v24, v8
    v_and_b32 v33, v24, v9
    v_and_b32 v34, v24, v10
    v_and_b32 v35, v24, v11
    s_waitcnt vmcnt(16)
    v_mfma_f32_16x16x32_bf16 v[40:43], v[36:39], v[120:123], v[40:43]
    v_mfma_f32_16x16x32_bf16 v[44:47], v[36:39], v[124:127], v[44:47]
    v_and_b32 v36, v25, v8
    v_and_b32 v37, v25, v9
    v_and_b32 v38, v25, v10
    v_and_b32 v39, v25, v11
    s_waitcnt vmcnt(14)
    v_mfma_f32_16x16x32_bf16 v[40:43], v[32:35], v[128:131], v[40:43]
    v_mfma_f32_16x16x32_bf16 v[44:47], v[32:35], v[132:135], v[44:47]
    v_and_b32 v32, v26, v8
    v_and_b32 v33, v26, v9
    v_and_b32 v34, v26, v10
    v_and_b32 v35, v26, v11
    s_waitcnt vmcnt(12)
    v_mfma_f32_16x16x32_bf16 v[40:43], v[36:39], v[136:139], v[40:43]
    v_mfma_f32_16x16x32_bf16 v[44:47], v[36:39], v[140:143], v[44:47]
    v_and_b32 v36, v27, v8
    v_and_b32 v37, v27, v9
    v_and_b32 v38, v27, v10
    v_and_b32 v39, v27, v11
    s_waitcnt vmcnt(10)
    v_mfma_f32_16x16x32_bf16 v[40:43], v[32:35], v[144:147], v[40:43]
    v_mfma_f32_16x16x32_bf16 v[44:47], v[32:35], v[148:151], v[44:47]
    v_and_b32 v32, v28, v8
    v_and_b32 v33, v28, v9
    v_and_b32 v34, v28, v10
    v_and_b32 v35, v28, v11
    s_waitcnt vmcnt(8)
    v_mfma_f32_16x16x32_bf16 v[40:43], v[36:39], v[152:155], v[40:43]
    v_mfma_f32_16x16x32_bf16 v[44:47], v[36:39], v[156:159], v[44:47]
    v_and_b32 v36, v29, v8
    v_and_b32 v37, v29, v9
    v_and_b32 v38, v29, v10
    v_and_b32 v39, v29, v11
    s_waitcnt vmcnt(6)
    v_mfma_f32_16x16x32_bf16 v[40:43], v[32:35], v[160:163], v[40:43]
    v_mfma_f32_16x16x32_bf16 v[44:47], v[32:35], v[164:167], v[44:47]
    v_and_b32 v32, v30, v8
    v_and_b32 v33, v30, v9
    v_and_b32 v34, v30, v10
    v_and_b32 v35, v30, v11
    s_waitcnt vmcnt(4)
    v_mfma_f32_16x16x32_bf16 v[40:43], v[36:39], v[168:171], v[40:43]
    v_mfma_f32_16x16x32_bf16 v[44:47], v[36:39], v[172:175], v[44:47]
    v_and_b32 v36, v31, v8
    v_and_b32 v37, v31, v9
    v_and_b32 v38, v31, v10
    v_and_b32 v39, v31, v11
    s_waitcnt vmcnt(2)
    v_mfma_f32_16x16x32_bf16 v[40:43], v[32:35], v[176:179], v[40:43]
    v_mfma_f32_16x16x32_bf16 v[44:47], v[32:35], v[180:183], v[44:47]
    s_waitcnt vmcnt(0)
    v_mfma_f32_16x16x32_bf16 v[40:43], v[36:39], v[184:187], v[40:43]
    v_mfma_f32_16x16x32_bf16 v[44:47], v[36:39], v[188:191], v[44:47]
    s_nop 7
    ds_write_b128 v49, v[40:43]
    ds_write_b128 v49, v[44:47] offset:1024
    s_waitcnt lgkmcnt(0)
    s_mov_b64 exec, 1
    ds_add_rtn_u32 v13, v12, v14 offset:16
    s_mov_b64 exec, -1
    s_waitcnt lgkmcnt(0)
    v_readfirstlane_b32 s58, v13
    s_cmp_eq_u32 s58, 3
    s_cbranch_scc0 L_vfin
    ds_read_b128 v[64:67], v48 offset:0
    ds_read_b128 v[68:71], v48 offset:1024
    ds_read_b128 v[72:75], v48 offset:2048
    ds_read_b128 v[76:79], v48 offset:3072
    ds_read_b128 v[80:83], v48 offset:4096
    ds_read_b128 v[84:87], v48 offset:5120
    ds_read_b128 v[88:91], v48 offset:6144
    ds_read_b128 v[92:95], v48 offset:7168
    s_waitcnt lgkmcnt(0)
    v_add_f32 v64, v64, v72
    v_add_f32 v80, v80, v88
    v_add_f32 v65, v65, v73
    v_add_f32 v81, v81, v89
    v_add_f32 v66, v66, v74
    v_add_f32 v82, v82, v90
    v_add_f32 v67, v67, v75
    v_add_f32 v83, v83, v91
    v_add_f32 v68, v68, v76
    v_add_f32 v84, v84, v92
    v_add_f32 v69, v69, v77
    v_add_f32 v85, v85, v93
    v_add_f32 v70, v70, v78
    v_add_f32 v86, v86, v94
    v_add_f32 v71, v71, v79
    v_add_f32 v87, v87, v95
    v_add_f32 v196, v64, v80
    v_add_f32 v197, v65, v81
    v_add_f32 v200, v66, v82
    v_add_f32 v201, v67, v83
    v_add_f32 v204, v68, v84
    v_add_f32 v205, v69, v85
    v_add_f32 v208, v70, v86
    v_add_f32 v209, v71, v87
    s_cmp_eq_u32 s97, 1
    s_cbranch_scc1 L_loc_7
    buffer_store_dwordx4 v[196:199], v51, s[36:39], s44 offen sc1
    buffer_store_dwordx4 v[200:203], v51, s[36:39], s44 offen offset:256 sc1
    buffer_store_dwordx4 v[204:207], v51, s[36:39], s45 offen sc1
    buffer_store_dwordx4 v[208:211], v51, s[36:39], s45 offen offset:256 sc1
    s_branch L_std_8
L_loc_7:
    buffer_store_dwordx4 v[196:199], v51, s[36:39], s44 offen
    buffer_store_dwordx4 v[200:203], v51, s[36:39], s44 offen offset:256
    buffer_store_dwordx4 v[204:207], v51, s[36:39], s45 offen
    buffer_store_dwordx4 v[208:211], v51, s[36:39], s45 offen offset:256
L_std_8:
    s_mov_b64 exec, 1
    ds_add_u32 v12, v14 offset:52
    s_mov_b64 exec, -1
L_vfin:
    s_cmp_eq_u32 s3, 6
    s_cbranch_scc0 L_nom3
    s_cmp_ge_u32 s29, 28
    s_cbranch_scc1 L_vend
    s_mul_i32 s52, s29, 37
    s_lshr_b32 s52, s52, 8
    s_mul_i32 s53, s52, 7
    s_sub_u32 s53, s29, s53
    s_lshr_b32 s54, s53, 1
    v_lshlrev_b32 v4, 6, v1
    s_lshl_b32 s55, s28, 5
    s_add_u32 s55, s55, s54
    s_lshl_b32 s55, s55, 4
    s_add_u32 s55, s55, 8192
    s_cmp_lt_u32 s28, 6
    s_cselect_b32 s48, 0xff, 0xf
    s_mov_b32 s49, 0
    v_lshrrev_b32 v5, 4, v1
    v_mul_u32_u24 v5, 7168, v5
    v_and_b32 v3, 15, v1
    v_lshl_add_u32 v5, v3, 4, v5
    s_mul_i32 s50, s52, 448
    s_lshl_b32 s51, s53, 6
    s_add_u32 s50, s50, s51
    s_mul_i32 s51, s28, 57344
    s_lshl_b32 s56, s50, 2
    s_add_u32 s51, s51, s56
    s_add_u32 s51, s51, 720896
    s_add_u32 s52, s51, 28672
    s_mov_b64 exec, s[48:49]
    s_mov_b32 s59, 0
L_pf_9:
    buffer_load_dwordx2 v[2:3], v4, s[36:39], s55 offen sc1
    s_waitcnt vmcnt(0)
    v_cmp_ne_u64 vcc, s[60:61], v[2:3]
    s_cbranch_vccz L_pd_10
    s_sleep 1
    s_add_u32 s59, s59, 1
    s_cmp_lt_u32 s59, 65536
    s_cbranch_scc1 L_pf_9
    s_mov_b32 s57, 9
    s_branch L_abort
L_pd_10:
    s_mov_b64 exec, -1
    v_mov_b32 v20, 0
    v_mov_b32 v21, 0
    v_mov_b32 v22, 0
    v_mov_b32 v23, 0
    buffer_load_dwordx4 v[16:19], v5, s[36:39], s51 offen sc1
    s_cmp_lt_u32 s28, 6
    s_cbranch_scc0 L_m3h
    buffer_load_dwordx4 v[20:23], v5, s[36:39], s52 offen sc1
L_m3h:
    v_and_b32 v3, 15, v1
    v_lshlrev_b32 v224, 5, v3
    v_bfe_u32 v3, v1, 4, 1
    v_lshl_add_u32 v224, v3, 4, v224
    s_lshl_b32 s96, s50, 3
    s_mul_i32 s56, s28, 14336
    s_add_u32 s96, s96, s56
    s_add_u32 s96, s96, 32768
    v_cmp_eq_u32 s[54:55], 1, v3
    s_waitcnt vmcnt(0)
    v_add_f32 v16, v16, v20
    v_add_f32 v17, v17, v21
    v_add_f32 v18, v18, v22
    v_add_f32 v19, v19, v23
    v_mov_b32 v20, v16
    v_mov_b32 v21, v17
    v_mov_b32 v22, v18
    v_mov_b32 v23, v19
    s_nop 0
    v_permlane16_swap_b32 v16, v20
    v_permlane16_swap_b32 v17, v21
    v_permlane16_swap_b32 v18, v22
    v_permlane16_swap_b32 v19, v23
    s_nop 1
    v_add_f32 v16, v16, v20
    v_add_f32 v17, v17, v21
    v_add_f32 v18, v18, v22
    v_add_f32 v19, v19, v23
    v_mov_b32 v20, v16
    v_mov_b32 v21, v17
    v_mov_b32 v22, v18
    v_mov_b32 v23, v19
    s_nop 0
    v_permlane32_swap_b32 v16, v20
    v_permlane32_swap_b32 v17, v21
    v_permlane32_swap_b32 v18, v22
    v_permlane32_swap_b32 v19, v23
    s_nop 1
    v_add_f32 v16, v16, v20
    v_add_f32 v17, v17, v21
    v_add_f32 v18, v18, v22
    v_add_f32 v19, v19, v23
    v_cndmask_b32 v220, v16, v18, s[54:55]
    v_cndmask_b32 v221, v17, v19, s[54:55]
    v_mov_b32 v222, s60
    v_mov_b32 v223, s61
    s_mov_b32 exec_hi, 0
    buffer_store_dwordx4 v[220:223], v224, s[36:39], s96 offen sc1
    s_mov_b32 exec_hi, -1
    s_branch L_vend
L_nom3:
    s_cmp_eq_u32 s3, 7
    s_cbranch_scc0 L_vend
    s_cmp_ge_u32 s2, 112
    s_cbranch_scc1 L_vend
    s_mul_i32 s62, s2, 2341
    s_lshr_b32 s62, s62, 16
    s_mul_i32 s63, s62, 28
    s_sub_u32 s63, s2, s63
    s_mul_i32 s53, s62, 448
    s_lshl_b32 s54, s63, 4
    s_add_u32 s53, s53, s54
    s_mov_b32 s40, s4
    s_mov_b32 s41, s5
    s_mov_b32 s42, 3584
    s_mov_b32 s43, 0x20000
    s_lshl_b32 s48, s53, 1
    v_and_b32 v3, 7, v1
    v_lshlrev_b32 v2, 2, v3
    buffer_load_dword v30, v2, s[40:43], s48 offen
    v_lshrrev_b32 v5, 3, v1
    v_mul_u32_u24 v6, 14336, v5
    v_lshl_add_u32 v6, v3, 4, v6
    v_mul_u32_u24 v7, 3584, v5
    v_lshl_add_u32 v7, v3, 4, v7
    s_lshl_b32 s53, s53, 3
    s_add_u32 s53, s53, 32768
    s_mul_i32 s52, s62, 229376
    s_lshl_b32 s54, s63, 7
    s_add_u32 s52, s52, s54
    s_add_u32 s52, s52, 2228224
    s_mov_b32 s40, s22
    s_mov_b32 s41, s23
    s_mov_b32 s59, 0
L_pg_11:
    buffer_load_dwordx4 v[16:19], v6, s[36:39], s53 offen sc1
    s_waitcnt vmcnt(0)
    v_cmp_ne_u64 vcc, s[60:61], v[18:19]
    s_cbranch_vccz L_pd_12
    s_sleep 2
    s_add_u32 s59, s59, 1
    s_cmp_lt_u32 s59, 65536
    s_cbranch_scc1 L_pg_11
    s_mov_b32 s57, 8
    s_branch L_abort
L_pd_12:
    s_nop 1
    v_add_f32_dpp v16, v16, v16 row_ror:8 row_mask:0xf bank_mask:0xf
    v_add_f32_dpp v17, v17, v17 row_ror:8 row_mask:0xf bank_mask:0xf
    v_mov_b32 v18, v16
    v_mov_b32 v19, v17
    s_nop 1
    v_permlane16_swap_b32 v16, v18
    v_permlane16_swap_b32 v17, v19
    s_nop 1
    v_add_f32 v16, v16, v18
    v_add_f32 v17, v17, v19
    v_mov_b32 v18, v16
    v_mov_b32 v19, v17
    s_nop 1
    v_permlane32_swap_b32 v16, v18
    v_permlane32_swap_b32 v17, v19
    s_nop 1
    v_add_f32 v16, v16, v18
    v_add_f32 v17, v17, v19
    v_cvt_pk_bf16_f32 v20, v16, v17
    v_lshlrev_b32 v16, 16, v20
    v_and_b32 v17, 0xffff0000, v20
    v_mul_f32 v20, 0xbfb8aa3b, v16
    v_mul_f32 v21, 0xbfb8aa3b, v17
    v_exp_f32 v20, v20
    v_exp_f32 v21, v21
    s_nop 0
    v_add_f32 v20, 1.0, v20
    v_add_f32 v21, 1.0, v21
    v_rcp_f32 v20, v20
    v_rcp_f32 v21, v21
    s_nop 0
    v_mul_f32 v16, v16, v20
    v_mul_f32 v17, v17, v21
    v_cvt_pk_bf16_f32 v20, v16, v17
    v_lshlrev_b32 v32, 16, v20
    v_and_b32 v33, 0xffff0000, v20
    v_lshlrev_b32 v34, 16, v30
    v_and_b32 v35, 0xffff0000, v30
    s_mov_b32 s59, 0
L_wf_13:
    ds_read_b32 v13, v12 offset:16
    s_waitcnt lgkmcnt(0)
    v_readfirstlane_b32 s58, v13
    s_cmp_ge_u32 s58, 4
    s_cbranch_scc1 L_wfd_14
    s_sleep 1
    s_add_u32 s59, s59, 1
    s_cmp_lt_u32 s59, 65536
    s_cbranch_scc1 L_wf_13
    s_mov_b32 s57, 15
    s_branch L_abort
L_wfd_14:
    v_mul_u32_u24 v24, 3584, v1
    v_mov_b32 v98, s60
    v_mov_b32 v99, s61
    v_mov_b32 v102, s60
    v_mov_b32 v103, s61
    v_mov_b32 v106, s60
    v_mov_b32 v107, s61
    s_mov_b32 s59, 0
L_pz_15:
    s_mov_b32 s53, s52
    buffer_load_dwordx4 v[64:67], v7, s[36:39], s53 offen sc1
    s_add_u32 s53, s53, 28672
    buffer_load_dwordx4 v[68:71], v7, s[36:39], s53 offen sc1
    s_add_u32 s53, s53, 28672
    buffer_load_dwordx4 v[72:75], v7, s[36:39], s53 offen sc1
    s_add_u32 s53, s53, 28672
    buffer_load_dwordx4 v[76:79], v7, s[36:39], s53 offen sc1
    s_add_u32 s53, s53, 28672
    buffer_load_dwordx4 v[80:83], v7, s[36:39], s53 offen sc1
    s_add_u32 s53, s53, 28672
    buffer_load_dwordx4 v[84:87], v7, s[36:39], s53 offen sc1
    s_add_u32 s53, s53, 28672
    buffer_load_dwordx4 v[88:91], v7, s[36:39], s53 offen sc1
    s_add_u32 s53, s53, 28672
    buffer_load_dwordx4 v[92:95], v7, s[36:39], s53 offen sc1
    s_cmp_eq_u32 s2, 111
    s_cbranch_scc0 L_noall
    s_mov_b32 s53, 2228224
    buffer_load_dwordx4 v[96:99], v24, s[36:39], s53 offen sc1
    s_mov_b32 s53, 2457600
    buffer_load_dwordx4 v[100:103], v24, s[36:39], s53 offen sc1
    s_mov_b32 s53, 2686976
    buffer_load_dwordx4 v[104:107], v24, s[36:39], s53 offen sc1
L_noall:
    s_waitcnt vmcnt(0)
    v_cmp_ne_u64 vcc, s[60:61], v[66:67]
    v_cmp_ne_u64 s[56:57], s[60:61], v[70:71]
    s_or_b64 vcc, vcc, s[56:57]
    v_cmp_ne_u64 s[56:57], s[60:61], v[74:75]
    s_or_b64 vcc, vcc, s[56:57]
    v_cmp_ne_u64 s[56:57], s[60:61], v[78:79]
    s_or_b64 vcc, vcc, s[56:57]
    v_cmp_ne_u64 s[56:57], s[60:61], v[82:83]
    s_or_b64 vcc, vcc, s[56:57]
    v_cmp_ne_u64 s[56:57], s[60:61], v[86:87]
    s_or_b64 vcc, vcc, s[56:57]
    v_cmp_ne_u64 s[56:57], s[60:61], v[90:91]
    s_or_b64 vcc, vcc, s[56:57]
    v_cmp_ne_u64 s[56:57], s[60:61], v[94:95]
    s_or_b64 vcc, vcc, s[56:57]
    v_cmp_ne_u64 s[56:57], s[60:61], v[98:99]
    s_or_b64 vcc, vcc, s[56:57]
    v_cmp_ne_u64 s[56:57], s[60:61], v[102:103]
    s_or_b64 vcc, vcc, s[56:57]
    v_cmp_ne_u64 s[56:57], s[60:61], v[106:107]
    s_or_b64 vcc, vcc, s[56:57]
    s_cbranch_vccz L_pd_16
    s_sleep 1
    s_add_u32 s59, s59, 1
    s_cmp_lt_u32 s59, 65536
    s_cbranch_scc1 L_pz_15
    s_mov_b32 s57, 13
    s_branch L_abort
L_pd_16:
    v_add_f32 v64, v64, v68
    v_add_f32 v65, v65, v69
    v_add_f32 v72, v72, v76
    v_add_f32 v73, v73, v77
    v_add_f32 v80, v80, v84
    v_add_f32 v81, v81, v85
    v_add_f32 v88, v88, v92
    v_add_f32 v89, v89, v93
    v_add_f32 v64, v64, v72
    v_add_f32 v65, v65, v73
    v_add_f32 v80, v80, v88
    v_add_f32 v81, v81, v89
    v_add_f32 v16, v64, v80
    v_add_f32 v17, v65, v81
    s_nop 1
    v_add_f32_dpp v16, v16, v16 row_ror:8 row_mask:0xf bank_mask:0xf
    v_add_f32_dpp v17, v17, v17 row_ror:8 row_mask:0xf bank_mask:0xf
    v_mov_b32 v18, v16
    v_mov_b32 v19, v17
    s_nop 1
    v_permlane16_swap_b32 v16, v18
    v_permlane16_swap_b32 v17, v19
    s_nop 1
    v_add_f32 v16, v16, v18
    v_add_f32 v17, v17, v19
    v_mov_b32 v18, v16
    v_mov_b32 v19, v17
    s_nop 1
    v_permlane32_swap_b32 v16, v18
    v_permlane32_swap_b32 v17, v19
    s_nop 1
    v_add_f32 v16, v16, v18
    v_add_f32 v17, v17, v19
    v_cvt_pk_bf16_f32 v20, v16, v17
    v_lshlrev_b32 v16, 16, v20
    v_and_b32 v17, 0xffff0000, v20
    v_mul_f32 v16, v16, v32
    v_mul_f32 v17, v17, v33
    v_cvt_pk_bf16_f32 v20, v16, v17
    v_lshlrev_b32 v16, 16, v20
    v_and_b32 v17, 0xffff0000, v20
    v_add_f32 v16, v16, v34
    v_add_f32 v17, v17, v35
    v_cvt_pk_bf16_f32 v20, v16, v17
    v_lshlrev_b32 v2, 2, v1
    s_mov_b64 exec, 0xff
    buffer_store_dword v20, v2, s[40:43], s48 offen
    s_cmp_eq_u32 s2, 111
    s_cbranch_scc0 L_vend
    s_mov_b64 exec, 1
    v_mov_b32 v2, s60
    v_mov_b32 v3, s61
    v_mov_b32 v4, 0
    buffer_store_dwordx2 v[2:3], v4, s[36:39], 0 offen sc1
L_vend:
    s_mov_b64 exec, -1
    s_endpgm
L_cw:
    v_lshlrev_b32 v3, 2, v1
    v_add_u32 v3, v12, v3
    v_mov_b32 v4, 0
    ds_write_b32 v3, v4
    v_lshlrev_b32 v4, 4, v1
    s_mul_i32 s52, s3, 896
    v_add_u32 v4, s52, v4
    v_mov_b32 v5, 0x7ffffff0
    v_cmp_le_u32 vcc, 56, v1
    s_getreg_b32 s99, hwreg(HW_REG_XCC_ID)
    s_waitcnt lgkmcnt(0)
    s_mov_b32 s40, s4
    s_mov_b32 s41, s5
    s_mov_b32 s42, 3584
    s_mov_b32 s43, 0x20000
    v_cndmask_b32 v4, v4, v5, vcc
    buffer_load_dwordx4 v[16:19], v4, s[40:43], 0 offen
    s_cmp_eq_u32 s3, 0
    s_cbranch_scc0 L_noep
    s_load_dwordx2 s[60:61], s[26:27], 0
L_noep:
    s_mov_b32 s36, s26
    s_mov_b32 s37, s27
    s_mov_b32 s38, 4456448
    s_mov_b32 s39, 0x20000
    s_barrier
    v_and_b32 v2, 1, v1
    v_lshlrev_b32 v2, 4, v2
    v_mov_b32 v3, 0xffff
    v_lshlrev_b32 v2, v2, v3
    v_bfe_u32 v3, v1, 1, 2
    v_cmp_eq_u32 vcc, 0, v3
    v_cmp_eq_u32 s[64:65], 1, v3
    v_cmp_eq_u32 s[66:67], 2, v3
    v_cmp_eq_u32 s[56:57], 3, v3
    s_nop 1
    v_cndmask_b32 v8, 0, v2, vcc
    v_cndmask_b32 v9, 0, v2, s[64:65]
    v_cndmask_b32 v10, 0, v2, s[66:67]
    v_cndmask_b32 v11, 0, v2, s[56:57]
    s_mul_i32 s52, s3, 1792
    s_add_u32 s52, s52, 135936
    v_lshlrev_b32 v6, 3, v1
    v_add_u32 v6, s52, v6
    v_bfe_u32 v2, v1, 3, 1
    v_lshlrev_b32 v2, 2, v2
    v_lshrrev_b32 v3, 4, v1
    v_add_u32 v2, v2, v3
    v_mul_u32_u24 v2, 448, v2
    s_mul_i32 s52, s63, 112
    s_lshl_b32 s53, s3, 2
    s_add_u32 s52, s52, s53
    s_add_u32 s52, s52, 135936
    v_add_u32 v7, s52, v2
    s_cmp_eq_u32 s3, 0
    s_cbranch_scc0 L_noep2
    s_waitcnt lgkmcnt(0)
    s_add_u32 s60, s60, 1
    s_addc_u32 s61, s61, 0
    v_mov_b32 v2, s60
    v_mov_b32 v3, s61
    ds_write_b64 v12, v[2:3] offset:32
    v_mov_b32 v20, s99
    v_mov_b32 v21, 0
    v_mov_b32 v22, s60
    v_mov_b32 v23, s61
    s_lshl_b32 s52, s28, 9
    s_lshl_b32 s53, s29, 4
    s_add_u32 s52, s52, s53
    s_add_u32 s52, s52, 12288
    v_mov_b32 v24, 0
    s_mov_b64 exec, 1
    buffer_store_dwordx4 v[20:23], v24, s[36:39], s52 offen sc1
    s_mov_b64 exec, -1
    s_waitcnt lgkmcnt(0)
    s_mov_b64 exec, 1
    ds_add_u32 v12, v14 offset:28
    s_mov_b64 exec, -1
L_noep2:
    s_lshl_b32 s52, s29, 12
    s_lshl_b32 s53, s3, 10
    s_add_u32 s52, s52, s53
    s_add_u32 s52, s52, 102400
    v_lshlrev_b32 v2, 4, v1
    s_and_b32 s52, s52, 0x1ffff
    v_add_u32 v96, s52, v2
    s_add_u32 s52, s52, 4096
    s_and_b32 s52, s52, 0x1ffff
    v_add_u32 v97, s52, v2
    s_add_u32 s52, s52, 4096
    s_and_b32 s52, s52, 0x1ffff
    v_add_u32 v98, s52, v2
    s_add_u32 s52, s52, 4096
    s_and_b32 s52, s52, 0x1ffff
    v_add_u32 v99, s52, v2
    s_add_u32 s52, s52, 4096
    s_and_b32 s52, s52, 0x1ffff
    v_add_u32 v100, s52, v2
    s_add_u32 s52, s52, 4096
    s_and_b32 s52, s52, 0x1ffff
    v_add_u32 v101, s52, v2
    s_add_u32 s52, s52, 4096
    s_and_b32 s52, s52, 0x1ffff
    v_add_u32 v102, s52, v2
    s_add_u32 s52, s52, 4096
    s_lshl_b32 s52, s3, 11
    s_add_u32 s52, s52, 151296
    v_add_u32 v103, s52, v2
    s_cmp_eq_u32 s3, 0
    s_cbranch_scc1 L_xw0
    s_waitcnt vmcnt(0)
    s_branch L_xw1
L_xw0:
    s_waitcnt vmcnt(1)
L_xw1:
    v_lshlrev_b32 v20, 16, v16
    v_and_b32 v21, 0xffff0000, v16
    v_lshlrev_b32 v22, 16, v17
    v_and_b32 v23, 0xffff0000, v17
    v_lshlrev_b32 v24, 16, v18
    v_and_b32 v25, 0xffff0000, v18
    v_lshlrev_b32 v26, 16, v19
    v_and_b32 v27, 0xffff0000, v19
    v_add_f32 v2, v20, v21
    v_add_f32 v3, v22, v23
    v_add_f32 v4, v24, v25
    v_add_f32 v5, v26, v27
    v_add_f32 v2, v2, v3
    v_add_f32 v4, v4, v5
    v_add_f32 v2, v2, v4
    s_nop 1
    v_add_f32_dpp v2, v2, v2 row_ror:8 row_mask:0xf bank_mask:0xf
    s_nop 1
    v_add_f32_dpp v2, v2, v2 row_ror:4 row_mask:0xf bank_mask:0xf
    s_nop 1
    v_add_f32_dpp v2, v2, v2 row_ror:2 row_mask:0xf bank_mask:0xf
    s_nop 1
    v_add_f32_dpp v2, v2, v2 row_ror:1 row_mask:0xf bank_mask:0xf
    v_mov_b32 v3, v2
    s_nop 1
    v_permlane16_swap_b32 v2, v3
    s_nop 1
    v_add_f32 v2, v2, v3
    v_mov_b32 v3, v2
    s_nop 1
    v_permlane32_swap_b32 v2, v3
    s_nop 1
    v_add_f32 v2, v2, v3
    v_mul_f32 v2, 0x3b124925, v2
    v_mov_b32 v4, 0
    v_mov_b32 v5, 0
    s_mov_b32 exec_hi, 0x00ffffff
    v_sub_f32 v28, v20, v2
    v_sub_f32 v29, v21, v2
    v_sub_f32 v30, v22, v2
    v_sub_f32 v31, v23, v2
    v_sub_f32 v32, v24, v2
    v_sub_f32 v33, v25, v2
    v_sub_f32 v34, v26, v2
    v_sub_f32 v35, v27, v2
    v_fmac_f32 v4, v28, v28
    v_fmac_f32 v5, v29, v29
    v_fmac_f32 v4, v30, v30
    v_fmac_f32 v5, v31, v31
    v_fmac_f32 v4, v32, v32
    v_fmac_f32 v5, v33, v33
    v_fmac_f32 v4, v34, v34
    v_fmac_f32 v5, v35, v35
    s_mov_b32 exec_hi, -1
    v_add_f32 v4, v4, v5
    s_nop 1
    v_add_f32_dpp v4, v4, v4 row_ror:8 row_mask:0xf bank_mask:0xf
    s_nop 1
    v_add_f32_dpp v4, v4, v4 row_ror:4 row_mask:0xf bank_mask:0xf
    s_nop 1
    v_add_f32_dpp v4, v4, v4 row_ror:2 row_mask:0xf bank_mask:0xf
    s_nop 1
    v_add_f32_dpp v4, v4, v4 row_ror:1 row_mask:0xf bank_mask:0xf
    v_mov_b32 v3, v4
    s_nop 1
    v_permlane16_swap_b32 v4, v3
    s_nop 1
    v_add_f32 v4, v4, v3
    v_mov_b32 v3, v4
    s_nop 1
    v_permlane32_swap_b32 v4, v3
    s_nop 1
    v_add_f32 v4, v4, v3
    v_mul_f32 v4, 0x3b124925, v4
    v_cvt_pk_bf16_f32 v3, v2, v4
    v_lshlrev_b32 v2, 16, v3
    v_and_b32 v4, 0xffff0000, v3
    v_add_f32 v4, 0x3727c5ac, v4
    v_cvt_pk_bf16_f32 v4, v4, v4
    v_and_b32 v4, 0xffff0000, v4
    v_sqrt_f32 v4, v4
    v_sub_f32 v20, v20, v2
    v_sub_f32 v21, v21, v2
    v_sub_f32 v22, v22, v2
    v_sub_f32 v23, v23, v2
    v_sub_f32 v24, v24, v2
    v_sub_f32 v25, v25, v2
    v_sub_f32 v26, v26, v2
    v_sub_f32 v27, v27, v2
    v_cvt_pk_bf16_f32 v4, v4, v4
    v_and_b32 v4, 0xffff0000, v4
    v_rcp_f32 v5, v4
    v_cvt_pk_bf16_f32 v16, v20, v21
    v_cvt_pk_bf16_f32 v17, v22, v23
    v_cvt_pk_bf16_f32 v18, v24, v25
    v_cvt_pk_bf16_f32 v19, v26, v27
    v_lshlrev_b32 v20, 16, v16
    v_and_b32 v21, 0xffff0000, v16
    v_lshlrev_b32 v22, 16, v17
    v_and_b32 v23, 0xffff0000, v17
    v_lshlrev_b32 v24, 16, v18
    v_and_b32 v25, 0xffff0000, v18
    v_lshlrev_b32 v26, 16, v19
    v_and_b32 v27, 0xffff0000, v19
    v_mul_f32 v28, v20, v5
    v_mul_f32 v29, v21, v5
    v_mul_f32 v30, v22, v5
    v_mul_f32 v31, v23, v5
    v_mul_f32 v32, v24, v5
    v_mul_f32 v33, v25, v5
    v_mul_f32 v34, v26, v5
    v_mul_f32 v35, v27, v5
    v_fma_f32 v20, -v28, v4, v20
    v_fma_f32 v21, -v29, v4, v21
    v_fma_f32 v22, -v30, v4, v22
    v_fma_f32 v23, -v31, v4, v23
    v_fma_f32 v24, -v32, v4, v24
    v_fma_f32 v25, -v33, v4, v25
    v_fma_f32 v26, -v34, v4, v26
    v_fma_f32 v27, -v35, v4, v27
    v_fmac_f32 v28, v20, v5
    v_fmac_f32 v29, v21, v5
    v_fmac_f32 v30, v22, v5
    v_fmac_f32 v31, v23, v5
    v_fmac_f32 v32, v24, v5
    v_fmac_f32 v33, v25, v5
    v_fmac_f32 v34, v26, v5
    v_fmac_f32 v35, v27, v5
    v_cvt_pk_bf16_f32 v40, v28, v28
    v_cvt_pk_bf16_f32 v41, v32, v32
    v_cvt_pk_bf16_f32 v42, v29, v29
    v_cvt_pk_bf16_f32 v43, v33, v33
    v_cvt_pk_bf16_f32 v44, v30, v30
    v_cvt_pk_bf16_f32 v45, v34, v34
    v_cvt_pk_bf16_f32 v46, v31, v31
    v_cvt_pk_bf16_f32 v47, v35, v35
    s_mov_b32 exec_hi, 0x00ffffff
    ds_write_b64 v6, v[40:41] offset:0
    ds_write_b64 v6, v[42:43] offset:448
    ds_write_b64 v6, v[44:45] offset:896
    ds_write_b64 v6, v[46:47] offset:1344
    s_mov_b32 exec_hi, -1
    s_waitcnt lgkmcnt(0)
    s_mov_b64 exec, 1
    ds_add_u32 v12, v14 offset:20
    s_mov_b64 exec, -1
    s_mov_b32 s59, 0
L_wf_17:
    ds_read_b32 v13, v12 offset:20
    s_waitcnt lgkmcnt(0)
    v_readfirstlane_b32 s58, v13
    s_cmp_ge_u32 s58, 4
    s_cbranch_scc1 L_wfd_18
    s_add_u32 s59, s59, 1
    s_cmp_lt_u32 s59, 65536
    s_cbranch_scc1 L_wf_17
    s_mov_b32 s57, 21
    s_branch L_abort
L_wfd_18:
    ds_read_b32 v48, v7 offset:0
    ds_read_b32 v49, v7 offset:16
    ds_read_b32 v50, v7 offset:32
    ds_read_b32 v51, v7 offset:48
    ds_read_b32 v52, v7 offset:64
    ds_read_b32 v53, v7 offset:80
    ds_read_b32 v54, v7 offset:96
    ds_read_b32 v55, v7 offset:3584
    ds_read_b32 v56, v7 offset:3600
    ds_read_b32 v57, v7 offset:3616
    ds_read_b32 v58, v7 offset:3632
    ds_read_b32 v59, v7 offset:3648
    ds_read_b32 v60, v7 offset:3664
    ds_read_b32 v61, v7 offset:3680
    s_mov_b32 s59, 0
L_wf_19:
    ds_read_b32 v13, v12 offset:24
    s_waitcnt lgkmcnt(0)
    v_readfirstlane_b32 s58, v13
    s_cmp_ge_u32 s58, 4
    s_cbranch_scc1 L_wfd_20
    s_add_u32 s59, s59, 1
    s_cmp_lt_u32 s59, 65536
    s_cbranch_scc1 L_wf_19
    s_mov_b32 s57, 22
    s_branch L_abort
L_wfd_20:
    ds_read_b128 v[64:67], v96
    ds_read_b128 v[68:71], v97
    ds_read_b128 v[72:75], v98
    ds_read_b128 v[76:79], v99
    ds_read_b128 v[80:83], v100
    ds_read_b128 v[84:87], v101
    ds_read_b128 v[88:91], v102
    s_waitcnt lgkmcnt(0)
    s_mov_b64 exec, 1
    ds_add_u32 v12, v14 offset:40
    s_mov_b64 exec, -1
    v_and_b32 v32, v48, v8
    v_and_b32 v33, v48, v9
    v_and_b32 v34, v48, v10
    v_and_b32 v35, v48, v11
    v_and_b32 v36, v55, v8
    v_and_b32 v37, v55, v9
    v_and_b32 v38, v55, v10
    v_and_b32 v39, v55, v11
    v_mfma_f32_16x16x32_bf16 v[40:43], v[32:35], v[64:67], 0
    v_and_b32 v32, v49, v8
    v_and_b32 v33, v49, v9
    v_and_b32 v34, v49, v10
    v_and_b32 v35, v49, v11
    v_mfma_f32_16x16x32_bf16 v[44:47], v[36:39], v[64:67], 0
    v_and_b32 v36, v56, v8
    v_and_b32 v37, v56, v9
    v_and_b32 v38, v56, v10
    v_and_b32 v39, v56, v11
    v_mfma_f32_16x16x32_bf16 v[40:43], v[32:35], v[68:71], v[40:43]
    v_and_b32 v32, v50, v8
    v_and_b32 v33, v50, v9
    v_and_b32 v34, v50, v10
    v_and_b32 v35, v50, v11
    v_mfma_f32_16x16x32_bf16 v[44:47], v[36:39], v[68:71], v[44:47]
    v_and_b32 v36, v57, v8
    v_and_b32 v37, v57, v9
    v_and_b32 v38, v57, v10
    v_and_b32 v39, v57, v11
    v_mfma_f32_16x16x32_bf16 v[40:43], v[32:35], v[72:75], v[40:43]
    v_and_b32 v32, v51, v8
    v_and_b32 v33, v51, v9
    v_and_b32 v34, v51, v10
    v_and_b32 v35, v51, v11
    v_mfma_f32_16x16x32_bf16 v[44:47], v[36:39], v[72:75], v[44:47]
    v_and_b32 v36, v58, v8
    v_and_b32 v37, v58, v9
    v_and_b32 v38, v58, v10
    v_and_b32 v39, v58, v11
    v_mfma_f32_16x16x32_bf16 v[40:43], v[32:35], v[76:79], v[40:43]
    v_and_b32 v32, v52, v8
    v_and_b32 v33, v52, v9
    v_and_b32 v34, v52, v10
    v_and_b32 v35, v52, v11
    v_mfma_f32_16x16x32_bf16 v[44:47], v[36:39], v[76:79], v[44:47]
    v_and_b32 v36, v59, v8
    v_and_b32 v37, v59, v9
    v_and_b32 v38, v59, v10
    v_and_b32 v39, v59, v11
    v_mfma_f32_16x16x32_bf16 v[40:43], v[32:35], v[80:83], v[40:43]
    v_and_b32 v32, v53, v8
    v_and_b32 v33, v53, v9
    v_and_b32 v34, v53, v10
    v_and_b32 v35, v53, v11
    v_mfma_f32_16x16x32_bf16 v[44:47], v[36:39], v[80:83], v[44:47]
    v_and_b32 v36, v60, v8
    v_and_b32 v37, v60, v9
    v_and_b32 v38, v60, v10
    v_and_b32 v39, v60, v11
    v_mfma_f32_16x16x32_bf16 v[40:43], v[32:35], v[84:87], v[40:43]
    v_and_b32 v32, v54, v8
    v_and_b32 v33, v54, v9
    v_and_b32 v34, v54, v10
    v_and_b32 v35, v54, v11
    v_mfma_f32_16x16x32_bf16 v[44:47], v[36:39], v[84:87], v[44:47]
    v_and_b32 v36, v61, v8
    v_and_b32 v37, v61, v9
    v_and_b32 v38, v61, v10
    v_and_b32 v39, v61, v11
    v_mfma_f32_16x16x32_bf16 v[40:43], v[32:35], v[88:91], v[40:43]
    s_nop 1
    v_mfma_f32_16x16x32_bf16 v[44:47], v[36:39], v[88:91], v[44:47]
    s_nop 7
    ds_write_b128 v103, v[40:43]
    ds_write_b128 v103, v[44:47] offset:1024
    s_waitcnt lgkmcnt(0)
    s_mov_b64 exec, 1
    ds_add_u32 v12, v14 offset:44
    s_mov_b64 exec, -1
    s_cmp_eq_u32 s3, 1
    s_cbranch_scc1 L_w1
    s_cmp_eq_u32 s3, 2
    s_cbranch_scc1 L_w2
    s_cmp_eq_u32 s3, 3
    s_cbranch_scc1 L_scores
    s_cmp_eq_u32 s98, 3
    s_cbranch_scc1 L_w0v
    v_lshlrev_b32 v2, 4, v1
    v_add_u32 v2, 151296, v2
    v_lshrrev_b32 v4, 5, v1
    v_lshlrev_b32 v4, 9, v4
    v_and_b32 v3, 15, v1
    v_lshl_add_u32 v4, v3, 5, v4
    v_bfe_u32 v3, v1, 4, 1
    v_lshl_add_u32 v4, v3, 4, v4
    s_lshl_b32 s54, s28, 5
    s_add_u32 s54, s54, s29
    s_lshl_b32 s55, s54, 4
    s_add_u32 s55, s55, 4096
    s_lshl_b32 s54, s54, 11
    s_add_u32 s54, s54, 196608
    s_mov_b32 s59, 0
L_wf_21:
    ds_read_b32 v13, v12 offset:44
    s_waitcnt lgkmcnt(0)
    v_readfirstlane_b32 s58, v13
    s_cmp_ge_u32 s58, 4
    s_cbranch_scc1 L_wfd_22
    s_add_u32 s59, s59, 1
    s_cmp_lt_u32 s59, 65536
    s_cbranch_scc1 L_wf_21
    s_mov_b32 s57, 23
    s_branch L_abort
L_wfd_22:
    ds_read_b128 v[64:67], v2 offset:0
    ds_read_b128 v[68:71], v2 offset:1024
    ds_read_b128 v[72:75], v2 offset:2048
    ds_read_b128 v[76:79], v2 offset:3072
    ds_read_b128 v[80:83], v2 offset:4096
    ds_read_b128 v[84:87], v2 offset:5120
    ds_read_b128 v[88:91], v2 offset:6144
    ds_read_b128 v[92:95], v2 offset:7168
    v_mov_b32 v2, s60
    v_mov_b32 v3, s61
    v_mov_b32 v5, 0
    s_waitcnt lgkmcnt(0)
    v_add_f32 v64, v64, v72
    v_add_f32 v80, v80, v88
    v_add_f32 v65, v65, v73
    v_add_f32 v81, v81, v89
    v_add_f32 v66, v66, v74
    v_add_f32 v82, v82, v90
    v_add_f32 v67, v67, v75
    v_add_f32 v83, v83, v91
    v_add_f32 v68, v68, v76
    v_add_f32 v84, v84, v92
    v_add_f32 v69, v69, v77
    v_add_f32 v85, v85, v93
    v_add_f32 v70, v70, v78
    v_add_f32 v86, v86, v94
    v_add_f32 v71, v71, v79
    v_add_f32 v87, v87, v95
    v_add_f32 v64, v64, v80
    v_add_f32 v65, v65, v81
    v_add_f32 v66, v66, v82
    v_add_f32 v67, v67, v83
    v_add_f32 v68, v68, v84
    v_add_f32 v69, v69, v85
    v_add_f32 v70, v70, v86
    v_add_f32 v71, v71, v87
    buffer_store_dwordx4 v[64:67], v4, s[36:39], s54 offen
    buffer_store_dwordx4 v[68:71], v4, s[36:39], s54 offen offset:1024
    s_waitcnt vmcnt(0)
    s_mov_b64 exec, 1
    buffer_store_dwordx2 v[2:3], v5, s[36:39], s55 offen
    s_mov_b64 exec, -1
    s_mov_b32 s34, s54
    s_mov_b32 s35, s55
    v_lshlrev_b32 v104, 4, v1
    s_lshl_b32 s52, s28, 9
    s_add_u32 s52, s52, 12288
    s_mov_b32 exec_hi, 0
    s_mov_b32 s59, 0
L_px_23:
    buffer_load_dwordx4 v[108:111], v104, s[36:39], s52 offen sc1
    s_waitcnt vmcnt(0)
    v_cmp_ne_u64 vcc, s[60:61], v[110:111]
    s_cbranch_vccz L_pd_24
    s_sleep 4
    s_add_u32 s59, s59, 1
    s_cmp_lt_u32 s59, 65536
    s_cbranch_scc1 L_px_23
    s_mov_b32 s57, 24
    s_branch L_abort
L_pd_24:
    v_cmp_ne_u32 vcc, s99, v108
    s_mov_b32 exec_hi, -1
    s_cmp_eq_u64 vcc, 0
    s_cselect_b32 s97, 1, 0
    v_mov_b32 v13, s97
    ds_write_b32 v12, v13 offset:56
    s_waitcnt lgkmcnt(0)
    s_mov_b64 exec, 1
    ds_add_u32 v12, v14 offset:60
    s_mov_b64 exec, -1
    s_cmp_eq_u32 s97, 1
    s_cbranch_scc1 L_scores
    s_add_u32 s35, s35, 20480
    v_mov_b32 v2, s60
    v_mov_b32 v3, s61
    buffer_store_dwordx4 v[64:67], v4, s[36:39], s34 offen sc1
    buffer_store_dwordx4 v[68:71], v4, s[36:39], s34 offen offset:1024 sc1
    s_waitcnt vmcnt(0)
    s_mov_b64 exec, 1
    buffer_store_dwordx2 v[2:3], v5, s[36:39], s35 offen sc1
    s_mov_b64 exec, -1
    s_branch L_scores
L_w0v:
    v_lshlrev_b32 v104, 4, v1
    s_lshl_b32 s52, s28, 9
    s_add_u32 s52, s52, 12288
    s_mov_b32 exec_hi, 0
    s_mov_b32 s59, 0
L_px_25:
    buffer_load_dwordx4 v[108:111], v104, s[36:39], s52 offen sc1
    s_waitcnt vmcnt(0)
    v_cmp_ne_u64 vcc, s[60:61], v[110:111]
    s_cbranch_vccz L_pd_26
    s_sleep 4
    s_add_u32 s59, s59, 1
    s_cmp_lt_u32 s59, 65536
    s_cbranch_scc1 L_px_25
    s_mov_b32 s57, 24
    s_branch L_abort
L_pd_26:
    v_cmp_ne_u32 vcc, s99, v108
    s_mov_b32 exec_hi, -1
    s_cmp_eq_u64 vcc, 0
    s_cselect_b32 s97, 1, 0
    v_mov_b32 v13, s97
    ds_write_b32 v12, v13 offset:56
    s_waitcnt lgkmcnt(0)
    s_mov_b64 exec, 1
    ds_add_u32 v12, v14 offset:60
    s_mov_b64 exec, -1
    s_branch L_scores
L_w1:
    s_mov_b32 s59, 0
L_wf_27:
    ds_read_b32 v13, v12 offset:28
    s_waitcnt lgkmcnt(0)
    v_readfirstlane_b32 s58, v13
    s_cmp_ge_u32 s58, 1
    s_cbranch_scc1 L_wfd_28
    s_sleep 1
    s_add_u32 s59, s59, 1
    s_cmp_lt_u32 s59, 65536
    s_cbranch_scc1 L_wf_27
    s_mov_b32 s57, 20
    s_branch L_abort
L_wfd_28:
    ds_read_b64 v[2:3], v12 offset:32
    s_waitcnt lgkmcnt(0)
    v_readfirstlane_b32 s60, v2
    v_readfirstlane_b32 s61, v3
    s_mov_b32 s59, 0
L_wf_29:
    ds_read_b32 v13, v12 offset:60
    s_waitcnt lgkmcnt(0)
    v_readfirstlane_b32 s58, v13
    s_cmp_ge_u32 s58, 1
    s_cbranch_scc1 L_wfd_30
    s_sleep 1
    s_add_u32 s59, s59, 1
    s_cmp_lt_u32 s59, 65536
    s_cbranch_scc1 L_wf_29
    s_mov_b32 s57, 25
    s_branch L_abort
L_wfd_30:
    ds_read_b32 v13, v12 offset:56
    s_waitcnt lgkmcnt(0)
    v_readfirstlane_b32 s97, v13
    v_lshlrev_b32 v4, 4, v1
    s_lshl_b32 s54, s28, 9
    s_add_u32 s54, s54, 4096
    s_cmp_eq_u32 s97, 1
    s_cselect_b32 s53, 0, 20480
    s_add_u32 s54, s54, s53
    v_lshrrev_b32 v5, 4, v1
    v_lshlrev_b32 v5, 13, v5
    v_and_b32 v3, 15, v1
    v_lshl_add_u32 v5, v3, 5, v5
    s_lshl_b32 s52, s28, 16
    s_lshl_b32 s53, s31, 9
    s_add_u32 s52, s52, s53
    s_add_u32 s52, s52, 196608
    s_add_u32 s53, s52, 4096
    v_lshlrev_b32 v6, 4, v1
    v_add_u32 v6, 131328, v6
    s_mov_b32 s59, 0
L_wf_31:
    ds_read_b32 v13, v12 offset:48
    s_waitcnt lgkmcnt(0)
    v_readfirstlane_b32 s58, v13
    s_cmp_ge_u32 s58, 4
    s_cbranch_scc1 L_wfd_32
    s_sleep 4
    s_add_u32 s59, s59, 1
    s_cmp_lt_u32 s59, 65536
    s_cbranch_scc1 L_wf_31
    s_mov_b32 s57, 40
    s_branch L_abort
L_wfd_32:
    s_mov_b64 exec, 0xffff
    s_mov_b32 s59, 0
L_pq_33:
    buffer_load_dwordx2 v[2:3], v4, s[36:39], s54 offen sc1
    s_waitcnt vmcnt(0)
    v_cmp_ne_u64 vcc, s[60:61], v[2:3]
    s_cbranch_vccz L_pd_34
    s_sleep 4
    s_add_u32 s59, s59, 1
    s_cmp_lt_u32 s59, 65536
    s_cbranch_scc1 L_pq_33
    s_mov_b32 s57, 2
    s_branch L_abort
L_pd_34:
    s_mov_b64 exec, -1
    buffer_load_dwordx4 v[16:19], v5, s[36:39], s52 offen offset:0 sc1
    buffer_load_dwordx4 v[20:23], v5, s[36:39], s52 offen offset:16 sc1
    buffer_load_dwordx4 v[24:27], v5, s[36:39], s52 offen offset:2048 sc1
    buffer_load_dwordx4 v[28:31], v5, s[36:39], s52 offen offset:2064 sc1
    buffer_load_dwordx4 v[32:35], v5, s[36:39], s53 offen offset:0 sc1
    buffer_load_dwordx4 v[36:39], v5, s[36:39], s53 offen offset:16 sc1
    buffer_load_dwordx4 v[40:43], v5, s[36:39], s53 offen offset:2048 sc1
    buffer_load_dwordx4 v[44:47], v5, s[36:39], s53 offen offset:2064 sc1
    s_waitcnt vmcnt(0)
    v_add_f32 v16, v16, v24
    v_add_f32 v32, v32, v40
    v_add_f32 v17, v17, v25
    v_add_f32 v33, v33, v41
    v_add_f32 v18, v18, v26
    v_add_f32 v34, v34, v42
    v_add_f32 v19, v19, v27
    v_add_f32 v35, v35, v43
    v_add_f32 v20, v20, v28
    v_add_f32 v36, v36, v44
    v_add_f32 v21, v21, v29
    v_add_f32 v37, v37, v45
    v_add_f32 v22, v22, v30
    v_add_f32 v38, v38, v46
    v_add_f32 v23, v23, v31
    v_add_f32 v39, v39, v47
    v_add_f32 v16, v16, v32
    v_add_f32 v17, v17, v33
    v_add_f32 v18, v18, v34
    v_add_f32 v19, v19, v35
    v_add_f32 v20, v20, v36
    v_add_f32 v21, v21, v37
    v_add_f32 v22, v22, v38
    v_add_f32 v23, v23, v39
    v_cvt_pk_bf16_f32 v24, v16, v17
    v_cvt_pk_bf16_f32 v25, v18, v19
    v_cvt_pk_bf16_f32 v26, v20, v21
    v_cvt_pk_bf16_f32 v27, v22, v23
    ds_write_b128 v6, v[24:27]
    s_waitcnt lgkmcnt(0)
    s_mov_b64 exec, 1
    ds_add_u32 v12, v14 offset:4
    s_mov_b64 exec, -1
    s_branch L_scores
L_w2:
    s_cmp_lt_u32 s28, 6
    s_cselect_b32 s58, 32, 16
    s_cmp_ge_u32 s29, s58
    s_cbranch_scc1 L_scores
    s_mov_b32 s59, 0
L_wf_35:
    ds_read_b32 v13, v12 offset:28
    s_waitcnt lgkmcnt(0)
    v_readfirstlane_b32 s58, v13
    s_cmp_ge_u32 s58, 1
    s_cbranch_scc1 L_wfd_36
    s_sleep 1
    s_add_u32 s59, s59, 1
    s_cmp_lt_u32 s59, 65536
    s_cbranch_scc1 L_wf_35
    s_mov_b32 s57, 20
    s_branch L_abort
L_wfd_36:
    ds_read_b64 v[2:3], v12 offset:32
    s_waitcnt lgkmcnt(0)
    v_readfirstlane_b32 s60, v2
    v_readfirstlane_b32 s61, v3
    s_mov_b32 s59, 0
L_wf_37:
    ds_read_b32 v13, v12 offset:60
    s_waitcnt lgkmcnt(0)
    v_readfirstlane_b32 s58, v13
    s_cmp_ge_u32 s58, 1
    s_cbranch_scc1 L_wfd_38
    s_sleep 1
    s_add_u32 s59, s59, 1
    s_cmp_lt_u32 s59, 65536
    s_cbranch_scc1 L_wf_37
    s_mov_b32 s57, 25
    s_branch L_abort
L_wfd_38:
    ds_read_b32 v13, v12 offset:56
    s_waitcnt lgkmcnt(0)
    v_readfirstlane_b32 s97, v13
    s_lshr_b32 s52, s29, 2
    s_and_b32 s53, s29, 3
    s_lshr_b32 s54, s52, 2
    v_lshrrev_b32 v2, 2, v1
    v_lshlrev_b32 v2, 3, v2
    v_and_b32 v3, 3, v1
    v_add_u32 v2, v2, v3
    v_lshlrev_b32 v4, 4, v2
    s_lshl_b32 s55, s28, 5
    s_lshl_b32 s56, s54, 2
    s_add_u32 s55, s55, s56
    s_add_u32 s55, s55, 16
    s_lshl_b32 s48, s55, 4
    s_add_u32 s48, s48, 4096
    s_cmp_eq_u32 s97, 1
    s_cselect_b32 s56, 0, 20480
    s_add_u32 s48, s48, s56
    v_lshrrev_b32 v5, 4, v1
    v_lshlrev_b32 v5, 9, v5
    v_and_b32 v3, 15, v1
    v_lshl_add_u32 v5, v3, 3, v5
    s_lshl_b32 s55, s55, 11
    s_and_b32 s56, s52, 3
    s_lshl_b32 s56, s56, 7
    s_add_u32 s55, s55, s56
    s_add_u32 s44, s55, 196608
    s_add_u32 s45, s44, 4096
    s_add_u32 s46, s44, 16384
    s_add_u32 s47, s46, 4096
    v_lshrrev_b32 v6, 4, v1
    v_lshlrev_b32 v6, 7, v6
    v_and_b32 v3, 1, v1
    v_lshl_add_u32 v6, v3, 6, v6
    v_bfe_u32 v3, v1, 1, 3
    v_lshl_add_u32 v6, v3, 2, v6
    v_add_u32 v6, 134400, v6
    v_bfe_u32 v7, v1, 3, 1
    v_lshlrev_b32 v7, 7, v7
    v_lshrrev_b32 v3, 4, v1
    v_lshl_add_u32 v7, v3, 5, v7
    v_add_u32 v7, 134400, v7
    v_lshlrev_b32 v15, 4, v1
    v_add_u32 v15, 143104, v15
    v_lshrrev_b32 v48, 5, v1
    v_mul_u32_u24 v48, 1792, v48
    v_and_b32 v3, 15, v1
    v_lshl_add_u32 v48, v3, 5, v48
    v_bfe_u32 v49, v1, 4, 1
    v_lshl_add_u32 v48, v49, 4, v48
    s_cmp_eq_u32 s53, 3
    s_cselect_b32 s54, 8, 16
    v_cmp_le_u32 vcc, s54, v3
    v_mov_b32 v49, 0x7ffffff0
    s_lshl_b32 s49, s28, 3
    s_add_u32 s49, s49, s52
    s_mul_i32 s49, s49, 7168
    s_lshl_b32 s55, s53, 9
    s_add_u32 s49, s49, s55
    s_add_u32 s49, s49, 720896
    s_add_u32 s50, s49, 3584
    v_cndmask_b32 v48, v48, v49, vcc
    s_lshl_b32 s51, s28, 5
    s_add_u32 s51, s51, s29
    s_lshl_b32 s51, s51, 4
    s_add_u32 s51, s51, 8192
    s_mov_b32 s59, 0
L_wf_39:
    ds_read_b32 v13, v12 offset:48
    s_waitcnt lgkmcnt(0)
    v_readfirstlane_b32 s58, v13
    s_cmp_ge_u32 s58, 4
    s_cbranch_scc1 L_wfd_40
    s_sleep 4
    s_add_u32 s59, s59, 1
    s_cmp_lt_u32 s59, 65536
    s_cbranch_scc1 L_wf_39
    s_mov_b32 s57, 41
    s_branch L_abort
L_wfd_40:
    ds_read_b128 v[64:67], v15 offset:0
    ds_read_b128 v[68:71], v15 offset:1024
    ds_read_b128 v[72:75], v15 offset:2048
    ds_read_b128 v[76:79], v15 offset:3072
    ds_read_b128 v[80:83], v15 offset:4096
    ds_read_b128 v[84:87], v15 offset:5120
    ds_read_b128 v[88:91], v15 offset:6144
    ds_read_b128 v[92:95], v15 offset:7168
    s_mov_b64 exec, 0xff
    s_mov_b32 s59, 0
L_pm_41:
    buffer_load_dwordx2 v[2:3], v4, s[36:39], s48 offen sc1
    s_waitcnt vmcnt(0)
    v_cmp_ne_u64 vcc, s[60:61], v[2:3]
    s_cbranch_vccz L_pd_42
    s_sleep 4
    s_add_u32 s59, s59, 1
    s_cmp_lt_u32 s59, 65536
    s_cbranch_scc1 L_pm_41
    s_mov_b32 s57, 3
    s_branch L_abort
L_pd_42:
    s_mov_b64 exec, -1
    buffer_load_dwordx2 v[16:17], v5, s[36:39], s44 offen offset:0 sc1
    buffer_load_dwordx2 v[18:19], v5, s[36:39], s44 offen offset:2048 sc1
    buffer_load_dwordx2 v[20:21], v5, s[36:39], s45 offen offset:0 sc1
    buffer_load_dwordx2 v[22:23], v5, s[36:39], s45 offen offset:2048 sc1
    buffer_load_dwordx2 v[24:25], v5, s[36:39], s46 offen offset:0 sc1
    buffer_load_dwordx2 v[26:27], v5, s[36:39], s46 offen offset:2048 sc1
    buffer_load_dwordx2 v[28:29], v5, s[36:39], s47 offen offset:0 sc1
    buffer_load_dwordx2 v[30:31], v5, s[36:39], s47 offen offset:2048 sc1
    s_waitcnt vmcnt(0)
    v_add_f32 v16, v16, v18
    v_add_f32 v20, v20, v22
    v_add_f32 v17, v17, v19
    v_add_f32 v21, v21, v23
    v_add_f32 v16, v16, v20
    v_add_f32 v17, v17, v21
    v_add_f32 v24, v24, v26
    v_add_f32 v28, v28, v30
    v_add_f32 v25, v25, v27
    v_add_f32 v29, v29, v31
    v_add_f32 v24, v24, v28
    v_add_f32 v25, v25, v29
    v_cvt_pk_bf16_f32 v2, v16, v17
    v_cvt_pk_bf16_f32 v3, v24, v25
    v_lshlrev_b32 v16, 16, v2
    v_and_b32 v17, 0xffff0000, v2
    v_lshlrev_b32 v24, 16, v3
    v_and_b32 v25, 0xffff0000, v3
    v_cmp_lt_f32 vcc, 0, v16
    v_cmp_lt_f32 s[54:55], 0, v17
    s_nop 1
    v_cndmask_b32 v2, 0, 1.0, vcc
    v_cndmask_b32 v3, 0, 1.0, s[54:55]
    v_mul_f32 v16, v16, v2
    v_mul_f32 v17, v17, v3
    v_mul_f32 v16, v16, v24
    v_mul_f32 v17, v17, v25
    v_cvt_pk_bf16_f32 v16, v16, v16
    v_cvt_pk_bf16_f32 v17, v17, v17
    ds_write_b32 v6, v16
    ds_write_b32 v6, v17 offset:32
    s_waitcnt lgkmcnt(0)
    ds_read_b128 v[16:19], v7
    ds_read_b128 v[20:23], v7 offset:16
    ds_read_b128 v[24:27], v7 offset:256
    ds_read_b128 v[28:31], v7 offset:272
    v_mov_b32 v4, s60
    v_mov_b32 v5, s61
    v_mov_b32 v6, 0
    s_waitcnt lgkmcnt(0)
    v_and_b32 v32, v16, v8
    v_and_b32 v33, v16, v9
    v_and_b32 v34, v16, v10
    v_and_b32 v35, v16, v11
    v_and_b32 v36, v24, v8
    v_and_b32 v37, v24, v9
    v_and_b32 v38, v24, v10
    v_and_b32 v39, v24, v11
    v_mfma_f32_16x16x32_bf16 v[40:43], v[32:35], v[64:67], 0
    v_and_b32 v32, v17, v8
    v_and_b32 v33, v17, v9
    v_and_b32 v34, v17, v10
    v_and_b32 v35, v17, v11
    v_mfma_f32_16x16x32_bf16 v[44:47], v[36:39], v[64:67], 0
    v_and_b32 v36, v25, v8
    v_and_b32 v37, v25, v9
    v_and_b32 v38, v25, v10
    v_and_b32 v39, v25, v11
    v_mfma_f32_16x16x32_bf16 v[40:43], v[32:35], v[68:71], v[40:43]
    v_and_b32 v32, v18, v8
    v_and_b32 v33, v18, v9
    v_and_b32 v34, v18, v10
    v_and_b32 v35, v18, v11
    v_mfma_f32_16x16x32_bf16 v[44:47], v[36:39], v[68:71], v[44:47]
    v_and_b32 v36, v26, v8
    v_and_b32 v37, v26, v9
    v_and_b32 v38, v26, v10
    v_and_b32 v39, v26, v11
    v_mfma_f32_16x16x32_bf16 v[40:43], v[32:35], v[72:75], v[40:43]
    v_and_b32 v32, v19, v8
    v_and_b32 v33, v19, v9
    v_and_b32 v34, v19, v10
    v_and_b32 v35, v19, v11
    v_mfma_f32_16x16x32_bf16 v[44:47], v[36:39], v[72:75], v[44:47]
    v_and_b32 v36, v27, v8
    v_and_b32 v37, v27, v9
    v_and_b32 v38, v27, v10
    v_and_b32 v39, v27, v11
    v_mfma_f32_16x16x32_bf16 v[40:43], v[32:35], v[76:79], v[40:43]
    v_and_b32 v32, v20, v8
    v_and_b32 v33, v20, v9
    v_and_b32 v34, v20, v10
    v_and_b32 v35, v20, v11
    v_mfma_f32_16x16x32_bf16 v[44:47], v[36:39], v[76:79], v[44:47]
    v_and_b32 v36, v28, v8
    v_and_b32 v37, v28, v9
    v_and_b32 v38, v28, v10
    v_and_b32 v39, v28, v11
    v_mfma_f32_16x16x32_bf16 v[40:43], v[32:35], v[80:83], v[40:43]
    v_and_b32 v32, v21, v8
    v_and_b32 v33, v21, v9
    v_and_b32 v34, v21, v10
    v_and_b32 v35, v21, v11
    v_mfma_f32_16x16x32_bf16 v[44:47], v[36:39], v[80:83], v[44:47]
    v_and_b32 v36, v29, v8
    v_and_b32 v37, v29, v9
    v_and_b32 v38, v29, v10
    v_and_b32 v39, v29, v11
    v_mfma_f32_16x16x32_bf16 v[40:43], v[32:35], v[84:87], v[40:43]
    v_and_b32 v32, v22, v8
    v_and_b32 v33, v22, v9
    v_and_b32 v34, v22, v10
    v_and_b32 v35, v22, v11
    v_mfma_f32_16x16x32_bf16 v[44:47], v[36:39], v[84:87], v[44:47]
    v_and_b32 v36, v30, v8
    v_and_b32 v37, v30, v9
    v_and_b32 v38, v30, v10
    v_and_b32 v39, v30, v11
    v_mfma_f32_16x16x32_bf16 v[40:43], v[32:35], v[88:91], v[40:43]
    v_and_b32 v32, v23, v8
    v_and_b32 v33, v23, v9
    v_and_b32 v34, v23, v10
    v_and_b32 v35, v23, v11
    v_mfma_f32_16x16x32_bf16 v[44:47], v[36:39], v[88:91], v[44:47]
    v_and_b32 v36, v31, v8
    v_and_b32 v37, v31, v9
    v_and_b32 v38, v31, v10
    v_and_b32 v39, v31, v11
    v_mfma_f32_16x16x32_bf16 v[40:43], v[32:35], v[92:95], v[40:43]
    s_nop 1
    v_mfma_f32_16x16x32_bf16 v[44:47], v[36:39], v[92:95], v[44:47]
    s_nop 7
    s_cmp_eq_u32 s97, 1
    s_cbranch_scc1 L_loc_43
    buffer_store_dwordx4 v[40:43], v48, s[36:39], s49 offen sc1
    buffer_store_dwordx4 v[44:47], v48, s[36:39], s50 offen sc1
    s_waitcnt vmcnt(0)
    s_mov_b64 exec, 1
    buffer_store_dwordx2 v[4:5], v6, s[36:39], s51 offen sc1
    s_mov_b64 exec, -1
    s_branch L_std_44
L_loc_43:
    buffer_store_dwordx4 v[40:43], v48, s[36:39], s49 offen
    buffer_store_dwordx4 v[44:47], v48, s[36:39], s50 offen
    s_waitcnt vmcnt(0)
    s_mov_b64 exec, 1
    buffer_store_dwordx2 v[4:5], v6, s[36:39], s51 offen
    s_mov_b64 exec, -1
L_std_44:
    s_branch L_scores
L_scores:
    v_and_b32 v2, 1, v1
    v_lshlrev_b32 v2, 9, v2
    v_lshrrev_b32 v3, 4, v1
    v_lshl_add_u32 v2, v3, 4, v2
    v_add_u32 v24, 131328, v2
    v_bfe_u32 v2, v1, 2, 2
    v_and_b32 v3, 3, v1
    v_lshl_add_u32 v4, v2, 4, v3
    s_lshl_b32 s52, s3, 2
    v_add_u32 v4, s52, v4
    v_lshlrev_b32 v4, 9, v4
    v_lshrrev_b32 v5, 4, v1
    v_xor_b32 v5, v5, v3
    v_lshl_add_u32 v4, v5, 4, v4
    v_xor_b32 v5, 0, v2
    v_lshl_add_u32 v16, v5, 6, v4
    v_add_u32 v20, 0x10000, v16
    v_xor_b32 v5, 1, v2
    v_lshl_add_u32 v17, v5, 6, v4
    v_add_u32 v21, 0x10000, v17
    v_xor_b32 v5, 2, v2
    v_lshl_add_u32 v18, v5, 6, v4
    v_add_u32 v22, 0x10000, v18
    v_xor_b32 v5, 3, v2
    v_lshl_add_u32 v19, v5, 6, v4
    v_add_u32 v23, 0x10000, v19
    v_lshrrev_b32 v6, 2, v1
    s_and_b32 s52, s29, 15
    v_subrev_u32 v6, s52, v6
    v_and_b32 v6, 15, v6
    v_lshlrev_b32 v6, 2, v6
    v_and_b32 v7, 3, v1
    v_lshl_add_u32 v6, v7, 6, v6
    s_lshl_b32 s52, s3, 9
    s_add_u32 s52, s52, 132352
    v_add_u32 v25, s52, v6
    s_lshl_b32 s52, s3, 3
    v_add_u32 v26, s52, v12
    s_mov_b32 s48, 0xffff0000
    s_mov_b32 s49, 0
    s_mov_b32 s50, 0
    s_mov_b32 s51, 0xffff
    s_mov_b32 s54, 0
    s_mov_b32 s55, 0xffff0000
    s_mov_b32 s59, 0
L_wf_45:
    ds_read_b32 v13, v12 offset:4
    s_waitcnt lgkmcnt(0)
    v_readfirstlane_b32 s58, v13
    s_cmp_ge_u32 s58, 1
    s_cbranch_scc1 L_wfd_46
    s_sleep 1
    s_add_u32 s59, s59, 1
    s_cmp_lt_u32 s59, 65536
    s_cbranch_scc1 L_wf_45
    s_mov_b32 s57, 4
    s_branch L_abort
L_wfd_46:
    ds_read_b128 v[64:67], v24 offset:0
    ds_read_b128 v[68:71], v24 offset:64
    ds_read_b128 v[72:75], v24 offset:128
    ds_read_b128 v[76:79], v24 offset:192
    ds_read_b128 v[80:83], v24 offset:256
    ds_read_b128 v[84:87], v24 offset:320
    ds_read_b128 v[88:91], v24 offset:384
    ds_read_b128 v[92:95], v24 offset:448
    s_mov_b32 s59, 0
L_wf_47:
    ds_read_b32 v13, v12 offset:0
    s_waitcnt lgkmcnt(0)
    v_readfirstlane_b32 s58, v13
    s_cmp_ge_u32 s58, 4
    s_cbranch_scc1 L_wfd_48
    s_sleep 1
    s_add_u32 s59, s59, 1
    s_cmp_lt_u32 s59, 65536
    s_cbranch_scc1 L_wf_47
    s_mov_b32 s57, 5
    s_branch L_abort
L_wfd_48:
    ds_read_b128 v[96:99], v16 offset:0
    ds_read_b128 v[100:103], v17 offset:0
    ds_read_b128 v[104:107], v18 offset:0
    ds_read_b128 v[108:111], v19 offset:0
    ds_read_b128 v[112:115], v16 offset:256
    ds_read_b128 v[116:119], v17 offset:256
    ds_read_b128 v[120:123], v18 offset:256
    ds_read_b128 v[124:127], v19 offset:256
    ds_read_b128 v[128:131], v16 offset:32768
    ds_read_b128 v[132:135], v17 offset:32768
    ds_read_b128 v[136:139], v18 offset:32768
    ds_read_b128 v[140:143], v19 offset:32768
    ds_read_b128 v[144:147], v16 offset:33024
    ds_read_b128 v[148:151], v17 offset:33024
    ds_read_b128 v[152:155], v18 offset:33024
    ds_read_b128 v[156:159], v19 offset:33024
    s_waitcnt lgkmcnt(8)
    v_mfma_f32_16x16x32_bf16 v[40:43], v[64:67], v[96:99], 0
    v_mfma_f32_16x16x32_bf16 v[40:43], v[68:71], v[100:103], v[40:43]
    v_mfma_f32_16x16x32_bf16 v[40:43], v[72:75], v[104:107], v[40:43]
    v_mfma_f32_16x16x32_bf16 v[40:43], v[76:79], v[108:111], v[40:43]
    v_mfma_f32_16x16x32_bf16 v[40:43], v[80:83], v[112:115], v[40:43]
    v_mfma_f32_16x16x32_bf16 v[40:43], v[84:87], v[116:119], v[40:43]
    v_mfma_f32_16x16x32_bf16 v[40:43], v[88:91], v[120:123], v[40:43]
    v_mfma_f32_16x16x32_bf16 v[40:43], v[92:95], v[124:127], v[40:43]
    ds_read_b128 v[96:99], v20 offset:0
    ds_read_b128 v[100:103], v21 offset:0
    ds_read_b128 v[104:107], v22 offset:0
    ds_read_b128 v[108:111], v23 offset:0
    ds_read_b128 v[112:115], v20 offset:256
    ds_read_b128 v[116:119], v21 offset:256
    ds_read_b128 v[120:123], v22 offset:256
    ds_read_b128 v[124:127], v23 offset:256
    s_waitcnt lgkmcnt(8)
    v_mfma_f32_16x16x32_bf16 v[44:47], v[64:67], v[128:131], 0
    v_mfma_f32_16x16x32_bf16 v[44:47], v[68:71], v[132:135], v[44:47]
    v_mfma_f32_16x16x32_bf16 v[44:47], v[72:75], v[136:139], v[44:47]
    v_mfma_f32_16x16x32_bf16 v[44:47], v[76:79], v[140:143], v[44:47]
    v_mfma_f32_16x16x32_bf16 v[44:47], v[80:83], v[144:147], v[44:47]
    v_mfma_f32_16x16x32_bf16 v[44:47], v[84:87], v[148:151], v[44:47]
    v_mfma_f32_16x16x32_bf16 v[44:47], v[88:91], v[152:155], v[44:47]
    v_mfma_f32_16x16x32_bf16 v[44:47], v[92:95], v[156:159], v[44:47]
    ds_read_b128 v[128:131], v20 offset:32768
    ds_read_b128 v[132:135], v21 offset:32768
    ds_read_b128 v[136:139], v22 offset:32768
    ds_read_b128 v[140:143], v23 offset:32768
    ds_read_b128 v[144:147], v20 offset:33024
    ds_read_b128 v[148:151], v21 offset:33024
    ds_read_b128 v[152:155], v22 offset:33024
    ds_read_b128 v[156:159], v23 offset:33024
    s_waitcnt lgkmcnt(8)
    v_mfma_f32_16x16x32_bf16 v[48:51], v[64:67], v[96:99], 0
    v_mfma_f32_16x16x32_bf16 v[48:51], v[68:71], v[100:103], v[48:51]
    v_mfma_f32_16x16x32_bf16 v[48:51], v[72:75], v[104:107], v[48:51]
    v_mfma_f32_16x16x32_bf16 v[48:51], v[76:79], v[108:111], v[48:51]
    v_mfma_f32_16x16x32_bf16 v[48:51], v[80:83], v[112:115], v[48:51]
    v_mfma_f32_16x16x32_bf16 v[48:51], v[84:87], v[116:119], v[48:51]
    v_mfma_f32_16x16x32_bf16 v[48:51], v[88:91], v[120:123], v[48:51]
    v_mfma_f32_16x16x32_bf16 v[48:51], v[92:95], v[124:127], v[48:51]
    s_waitcnt lgkmcnt(0)
    v_mfma_f32_16x16x32_bf16 v[52:55], v[64:67], v[128:131], 0
    v_mfma_f32_16x16x32_bf16 v[52:55], v[68:71], v[132:135], v[52:55]
    v_mfma_f32_16x16x32_bf16 v[52:55], v[72:75], v[136:139], v[52:55]
    v_mfma_f32_16x16x32_bf16 v[52:55], v[76:79], v[140:143], v[52:55]
    v_mfma_f32_16x16x32_bf16 v[52:55], v[80:83], v[144:147], v[52:55]
    v_mfma_f32_16x16x32_bf16 v[52:55], v[84:87], v[148:151], v[52:55]
    v_mfma_f32_16x16x32_bf16 v[52:55], v[88:91], v[152:155], v[52:55]
    v_mfma_f32_16x16x32_bf16 v[52:55], v[92:95], v[156:159], v[52:55]
    s_nop 7
    v_cndmask_b32 v2, v40, v44, s[48:49]
    v_cndmask_b32 v3, v41, v45, s[48:49]
    v_cndmask_b32 v2, v2, v48, s[50:51]
    v_cndmask_b32 v3, v3, v49, s[50:51]
    v_cndmask_b32 v2, v2, v52, s[54:55]
    v_cndmask_b32 v3, v3, v53, s[54:55]
    v_cvt_pk_bf16_f32 v4, v2, v3
    v_lshlrev_b32 v2, 16, v4
    v_and_b32 v3, 0xffff0000, v4
    v_mov_b32 v4, v2
    v_mov_b32 v5, v3
    s_nop 0
    v_max_f32_dpp v4, v4, v4 row_ror:8 row_mask:0xf bank_mask:0xf
    v_max_f32_dpp v5, v5, v5 row_ror:8 row_mask:0xf bank_mask:0xf
    s_nop 0
    v_max_f32_dpp v4, v4, v4 row_ror:4 row_mask:0xf bank_mask:0xf
    v_max_f32_dpp v5, v5, v5 row_ror:4 row_mask:0xf bank_mask:0xf
    s_nop 0
    v_max_f32_dpp v4, v4, v4 row_ror:2 row_mask:0xf bank_mask:0xf
    v_max_f32_dpp v5, v5, v5 row_ror:2 row_mask:0xf bank_mask:0xf
    s_nop 0
    v_max_f32_dpp v4, v4, v4 row_ror:1 row_mask:0xf bank_mask:0xf
    v_max_f32_dpp v5, v5, v5 row_ror:1 row_mask:0xf bank_mask:0xf
    v_mov_b32 v6, v4
    v_mov_b32 v7, v5
    s_nop 1
    v_permlane16_swap_b32 v4, v6
    v_permlane16_swap_b32 v5, v7
    s_nop 1
    v_max_f32 v4, v4, v6
    v_max_f32 v5, v5, v7
    v_mov_b32 v6, v4
    v_mov_b32 v7, v5
    s_nop 1
    v_permlane32_swap_b32 v4, v6
    v_permlane32_swap_b32 v5, v7
    s_nop 1
    v_max_f32 v4, v4, v6
    v_max_f32 v5, v5, v7
    s_mov_b64 exec, 1
    ds_write_b64 v26, v[4:5] offset:64
    s_waitcnt lgkmcnt(0)
    ds_add_u32 v12, v14 offset:8
    s_mov_b64 exec, -1
    s_mov_b32 s59, 0
L_wf_49:
    ds_read_b32 v13, v12 offset:8
    s_waitcnt lgkmcnt(0)
    v_readfirstlane_b32 s58, v13
    s_cmp_ge_u32 s58, 4
    s_cbranch_scc1 L_wfd_50
    s_add_u32 s59, s59, 1
    s_cmp_lt_u32 s59, 65536
    s_cbranch_scc1 L_wf_49
    s_mov_b32 s57, 6
    s_branch L_abort
L_wfd_50:
    ds_read_b128 v[16:19], v12 offset:64
    ds_read_b128 v[20:23], v12 offset:80
    s_waitcnt lgkmcnt(0)
    v_max3_f32 v4, v16, v18, v20
    v_max3_f32 v5, v17, v19, v21
    v_max_f32 v4, v4, v22
    v_max_f32 v5, v5, v23
    v_sub_f32 v2, v2, v4
    v_sub_f32 v3, v3, v5
    v_mul_f32 v2, 0x3db8aa3b, v2
    v_mul_f32 v3, 0x3db8aa3b, v3
    v_exp_f32 v2, v2
    v_exp_f32 v3, v3
    s_nop 0
    v_cvt_pk_bf16_f32 v16, v2, v2
    v_cvt_pk_bf16_f32 v17, v3, v3
    ds_write_b32 v25, v16
    ds_write_b32 v25, v17 offset:256
    s_nop 0
    v_add_f32_dpp v2, v2, v2 row_ror:8 row_mask:0xf bank_mask:0xf
    v_add_f32_dpp v3, v3, v3 row_ror:8 row_mask:0xf bank_mask:0xf
    s_nop 0
    v_add_f32_dpp v2, v2, v2 row_ror:4 row_mask:0xf bank_mask:0xf
    v_add_f32_dpp v3, v3, v3 row_ror:4 row_mask:0xf bank_mask:0xf
    s_nop 0
    v_add_f32_dpp v2, v2, v2 row_ror:2 row_mask:0xf bank_mask:0xf
    v_add_f32_dpp v3, v3, v3 row_ror:2 row_mask:0xf bank_mask:0xf
    s_nop 0
    v_add_f32_dpp v2, v2, v2 row_ror:1 row_mask:0xf bank_mask:0xf
    v_add_f32_dpp v3, v3, v3 row_ror:1 row_mask:0xf bank_mask:0xf
    v_mov_b32 v6, v2
    v_mov_b32 v7, v3
    s_nop 1
    v_permlane16_swap_b32 v2, v6
    v_permlane16_swap_b32 v3, v7
    s_nop 1
    v_add_f32 v2, v2, v6
    v_add_f32 v3, v3, v7
    v_mov_b32 v6, v2
    v_mov_b32 v7, v3
    s_nop 1
    v_permlane32_swap_b32 v2, v6
    v_permlane32_swap_b32 v3, v7
    s_nop 1
    v_add_f32 v2, v2, v6
    v_add_f32 v3, v3, v7
    s_mov_b64 exec, 1
    ds_write_b64 v26, v[2:3] offset:96
    s_waitcnt lgkmcnt(0)
    ds_add_rtn_u32 v13, v12, v14 offset:12
    s_waitcnt lgkmcnt(0)
    s_mov_b64 exec, -1
    v_readfirstlane_b32 s58, v13
    s_cmp_eq_u32 s58, 3
    s_cbranch_scc0 L_noml
    s_mov_b32 s59, 0
L_wf_51:
    ds_read_b32 v13, v12 offset:28
    s_waitcnt lgkmcnt(0)
    v_readfirstlane_b32 s58, v13
    s_cmp_ge_u32 s58, 1
    s_cbranch_scc1 L_wfd_52
    s_sleep 1
    s_add_u32 s59, s59, 1
    s_cmp_lt_u32 s59, 65536
    s_cbranch_scc1 L_wf_51
    s_mov_b32 s57, 20
    s_branch L_abort
L_wfd_52:
    ds_read_b64 v[2:3], v12 offset:32
    s_waitcnt lgkmcnt(0)
    v_readfirstlane_b32 s60, v2
    v_readfirstlane_b32 s61, v3
    s_mov_b32 s59, 0
L_wf_53:
    ds_read_b32 v13, v12 offset:60
    s_waitcnt lgkmcnt(0)
    v_readfirstlane_b32 s58, v13
    s_cmp_ge_u32 s58, 1
    s_cbranch_scc1 L_wfd_54
    s_sleep 1
    s_add_u32 s59, s59, 1
    s_cmp_lt_u32 s59, 65536
    s_cbranch_scc1 L_wf_53
    s_mov_b32 s57, 25
    s_branch L_abort
L_wfd_54:
    ds_read_b32 v13, v12 offset:56
    s_waitcnt lgkmcnt(0)
    v_readfirstlane_b32 s97, v13
    ds_read_b128 v[16:19], v12 offset:96
    ds_read_b128 v[20:23], v12 offset:112
    v_cmp_eq_u32 vcc, 1, v1
    v_lshlrev_b32 v6, 4, v1
    s_lshl_b32 s52, s32, 8
    s_lshl_b32 s53, s30, 5
    s_add_u32 s52, s52, s53
    s_add_u32 s52, s52, 16384
    s_waitcnt lgkmcnt(0)
    v_add_f32 v16, v16, v18
    v_add_f32 v17, v17, v19
    v_add_f32 v20, v20, v22
    v_add_f32 v21, v21, v23
    v_add_f32 v16, v16, v20
    v_add_f32 v17, v17, v21
    v_mov_b32 v18, s60
    v_mov_b32 v19, s61
    v_cndmask_b32 v17, v16, v17, vcc
    v_cndmask_b32 v16, v4, v5, vcc
    s_mov_b64 exec, 3
    s_cmp_eq_u32 s97, 1
    s_cbranch_scc1 L_loc_55
    buffer_store_dwordx4 v[16:19], v6, s[36:39], s52 offen sc1
    s_branch L_std_56
L_loc_55:
    buffer_store_dwordx4 v[16:19], v6, s[36:39], s52 offen
L_std_56:
    s_mov_b64 exec, -1
L_noml:
    s_mov_b32 s59, 0
L_wf_57:
    ds_read_b32 v13, v12 offset:28
    s_waitcnt lgkmcnt(0)
    v_readfirstlane_b32 s58, v13
    s_cmp_ge_u32 s58, 1
    s_cbranch_scc1 L_wfd_58
    s_sleep 1
    s_add_u32 s59, s59, 1
    s_cmp_lt_u32 s59, 65536
    s_cbranch_scc1 L_wf_57
    s_mov_b32 s57, 20
    s_branch L_abort
L_wfd_58:
    ds_read_b64 v[2:3], v12 offset:32
    s_waitcnt lgkmcnt(0)
    v_readfirstlane_b32 s60, v2
    v_readfirstlane_b32 s61, v3
    s_mov_b32 s44, s12
    s_mov_b32 s45, s13
    s_mov_b32 s46, 3670016
    s_mov_b32 s47, 0x20000
    v_lshrrev_b32 v2, 4, v1
    v_mul_u32_u24 v2, 896, v2
    v_and_b32 v3, 15, v1
    v_lshl_add_u32 v5, v3, 4, v2
    s_cmp_eq_u32 s3, 3
    s_cselect_b32 s54, 8, 16
    v_cmp_le_u32 vcc, s54, v3
    v_mov_b32 v6, 0x7ffffff0
    s_lshl_b32 s52, s28, 9
    s_lshl_b32 s53, s30, 5
    s_add_u32 s52, s52, s53
    s_mul_i32 s52, s52, 896
    s_lshl_b32 s53, s3, 8
    s_add_u32 s52, s52, s53
    v_cndmask_b32 v46, v5, v6, vcc
    v_add_u32 v47, 7168, v46
    s_add_u32 s53, s31, 0
    s_and_b32 s53, s53, 3
    s_mul_i32 s40, s53, 14336
    s_cmp_ge_u32 s53, 2
    s_cselect_b32 s53, 200704, 0
    s_add_u32 s40, s40, s53
    s_add_u32 s40, s40, s52
    s_add_u32 s53, s31, 1
    s_and_b32 s53, s53, 3
    s_mul_i32 s41, s53, 14336
    s_cmp_ge_u32 s53, 2
    s_cselect_b32 s53, 200704, 0
    s_add_u32 s41, s41, s53
    s_add_u32 s41, s41, s52
    s_add_u32 s53, s31, 2
    s_and_b32 s53, s53, 3
    s_mul_i32 s42, s53, 14336
    s_cmp_ge_u32 s53, 2
    s_cselect_b32 s53, 200704, 0
    s_add_u32 s42, s42, s53
    s_add_u32 s42, s42, s52
    s_add_u32 s53, s31, 3
    s_and_b32 s53, s53, 3
    s_mul_i32 s43, s53, 14336
    s_cmp_ge_u32 s53, 2
    s_cselect_b32 s53, 200704, 0
    s_add_u32 s43, s43, s53
    s_add_u32 s43, s43, s52
    v_lshrrev_b32 v2, 5, v1
    v_mul_u32_u24 v2, 2048, v2
    v_and_b32 v3, 31, v1
    v_lshl_add_u32 v48, v3, 4, v2
    v_bfe_u32 v3, v1, 3, 1
    v_lshrrev_b32 v45, 5, v1
    v_lshlrev_b32 v45, 7, v45
    v_lshl_add_u32 v45, v3, 4, v45
    s_lshl_b32 s34, s32, 8
    s_add_u32 s34, s34, 16384
    s_mul_i32 s48, s32, 32768
    s_mul_i32 s53, s30, 4096
    s_add_u32 s48, s48, s53
    s_add_u32 s48, s48, 1179648
    v_bfe_u32 v2, v1, 4, 1
    v_lshlrev_b32 v2, 7, v2
    v_and_b32 v3, 15, v1
    s_lshl_b32 s53, s31, 2
    v_subrev_u32 v3, s53, v3
    v_and_b32 v3, 15, v3
    v_lshl_add_u32 v2, v3, 2, v2
    s_lshl_b32 s53, s3, 8
    s_add_u32 s53, s53, 134912
    v_add_u32 v49, s53, v2
    v_lshrrev_b32 v3, 4, v1
    v_lshlrev_b32 v3, 6, v3
    v_add_u32 v50, s53, v3
    v_and_b32 v2, 15, v1
    v_lshlrev_b32 v2, 6, v2
    v_bfe_u32 v3, v1, 4, 1
    v_lshl_add_u32 v2, v3, 5, v2
    v_lshrrev_b32 v3, 5, v1
    v_lshl_add_u32 v51, v3, 4, v2
    v_and_b32 v3, 15, v1
    s_cmp_eq_u32 s3, 3
    s_cselect_b32 s54, 8, 16
    v_cmp_le_u32 vcc, s54, v3
    s_lshl_b32 s49, s31, 6
    s_lshl_b32 s53, s28, 3
    s_add_u32 s49, s49, s53
    s_add_u32 s49, s49, s30
    s_mul_i32 s49, s49, 3584
    s_lshl_b32 s53, s3, 10
    s_add_u32 s49, s49, s53
    s_add_u32 s49, s49, 2228224
    v_cndmask_b32 v51, v51, v6, vcc
    v_mov_b32 v54, s60
    v_mov_b32 v55, s61
    v_cmp_le_u32 s[50:51], 32, v1
    s_barrier
    buffer_load_dwordx4 v[128:131], v45, s[36:39], s34 offen offset:0 sc1
    buffer_load_dwordx4 v[132:135], v45, s[36:39], s34 offen offset:32 sc1
    buffer_load_dwordx4 v[136:139], v45, s[36:39], s34 offen offset:64 sc1
    buffer_load_dwordx4 v[140:143], v45, s[36:39], s34 offen offset:96 sc1
    buffer_load_dwordx4 v[64:67], v46, s[44:47], s40 offen offset:0 nt
    buffer_load_dwordx4 v[68:71], v46, s[44:47], s40 offen offset:3584 nt
    buffer_load_dwordx4 v[72:75], v47, s[44:47], s40 offen offset:0 nt
    buffer_load_dwordx4 v[76:79], v47, s[44:47], s40 offen offset:3584 nt
    buffer_load_dwordx4 v[80:83], v46, s[44:47], s41 offen offset:0 nt
    buffer_load_dwordx4 v[84:87], v46, s[44:47], s41 offen offset:3584 nt
    buffer_load_dwordx4 v[88:91], v47, s[44:47], s41 offen offset:0 nt
    buffer_load_dwordx4 v[92:95], v47, s[44:47], s41 offen offset:3584 nt
    buffer_load_dwordx4 v[96:99], v46, s[44:47], s42 offen offset:0 nt
    buffer_load_dwordx4 v[100:103], v46, s[44:47], s42 offen offset:3584 nt
    buffer_load_dwordx4 v[104:107], v47, s[44:47], s42 offen offset:0 nt
    buffer_load_dwordx4 v[108:111], v47, s[44:47], s42 offen offset:3584 nt
    buffer_load_dwordx4 v[112:115], v46, s[44:47], s43 offen offset:0 nt
    buffer_load_dwordx4 v[116:119], v46, s[44:47], s43 offen offset:3584 nt
    buffer_load_dwordx4 v[120:123], v47, s[44:47], s43 offen offset:0 nt
    buffer_load_dwordx4 v[124:127], v47, s[44:47], s43 offen offset:3584 nt
    s_waitcnt vmcnt(16)
    v_cmp_ne_u64 vcc, s[60:61], v[130:131]
    v_cmp_ne_u64 s[56:57], s[60:61], v[134:135]
    s_or_b64 vcc, vcc, s[56:57]
    v_cmp_ne_u64 s[56:57], s[60:61], v[138:139]
    s_or_b64 vcc, vcc, s[56:57]
    v_cmp_ne_u64 s[56:57], s[60:61], v[142:143]
    s_or_b64 vcc, vcc, s[56:57]
    s_cbranch_vccz L_mlok_59
    s_mov_b32 s59, 0
L_pml_60:
    buffer_load_dwordx4 v[128:131], v45, s[36:39], s34 offen offset:0 sc1
    buffer_load_dwordx4 v[132:135], v45, s[36:39], s34 offen offset:32 sc1
    buffer_load_dwordx4 v[136:139], v45, s[36:39], s34 offen offset:64 sc1
    buffer_load_dwordx4 v[140:143], v45, s[36:39], s34 offen offset:96 sc1
    s_waitcnt vmcnt(0)
    v_cmp_ne_u64 vcc, s[60:61], v[130:131]
    v_cmp_ne_u64 s[56:57], s[60:61], v[134:135]
    s_or_b64 vcc, vcc, s[56:57]
    v_cmp_ne_u64 s[56:57], s[60:61], v[138:139]
    s_or_b64 vcc, vcc, s[56:57]
    v_cmp_ne_u64 s[56:57], s[60:61], v[142:143]
    s_or_b64 vcc, vcc, s[56:57]
    s_cbranch_vccz L_pd_61
    s_sleep 2
    s_add_u32 s59, s59, 1
    s_cmp_lt_u32 s59, 65536
    s_cbranch_scc1 L_pml_60
    s_mov_b32 s57, 10
    s_branch L_abort
L_pd_61:
L_mlok_59:
    v_max_f32 v144, v128, v132
    v_max_f32 v145, v136, v140
    v_max_f32 v144, v144, v145
    v_mov_b32 v145, v144
    s_nop 1
    v_permlane32_swap_b32 v144, v145
    s_nop 1
    v_max_f32 v144, v144, v145
    v_sub_f32 v146, v128, v144
    v_sub_f32 v147, v132, v144
    v_sub_f32 v148, v136, v144
    v_sub_f32 v149, v140, v144
    v_mul_f32 v146, 0x3db8aa3b, v146
    v_mul_f32 v147, 0x3db8aa3b, v147
    v_mul_f32 v148, 0x3db8aa3b, v148
    v_mul_f32 v149, 0x3db8aa3b, v149
    v_exp_f32 v146, v146
    v_exp_f32 v147, v147
    v_exp_f32 v148, v148
    v_exp_f32 v149, v149
    s_nop 0
    v_mul_f32 v150, v146, v129
    v_fmac_f32 v150, v147, v133
    v_fmac_f32 v150, v148, v137
    v_fmac_f32 v150, v149, v141
    v_mov_b32 v151, v150
    s_nop 1
    v_permlane32_swap_b32 v150, v151
    s_nop 1
    v_add_f32 v150, v150, v151
    v_rcp_f32 v151, v150
    s_nop 0
    v_fma_f32 v152, -v150, v151, 1.0
    v_fmac_f32 v151, v152, v151
    v_mul_f32 v146, v146, v151
    v_mul_f32 v147, v147, v151
    v_mul_f32 v148, v148, v151
    v_mul_f32 v149, v149, v151
    s_mov_b32 s59, 0
L_wf_62:
    ds_read_b32 v13, v12 offset:52
    s_waitcnt lgkmcnt(0)
    v_readfirstlane_b32 s58, v13
    s_cmp_ge_u32 s58, 1
    s_cbranch_scc1 L_wfd_63
    s_add_u32 s59, s59, 1
    s_cmp_lt_u32 s59, 65536
    s_cbranch_scc1 L_wf_62
    s_mov_b32 s57, 11
    s_branch L_abort
L_wfd_63:
    s_mov_b32 s59, 0
L_po_64:
    buffer_load_dwordx4 v[16:19], v48, s[36:39], s48 offen offset:0 sc1
    buffer_load_dwordx4 v[20:23], v48, s[36:39], s48 offen offset:512 sc1
    buffer_load_dwordx4 v[24:27], v48, s[36:39], s48 offen offset:1024 sc1
    buffer_load_dwordx4 v[28:31], v48, s[36:39], s48 offen offset:1536 sc1
    s_waitcnt vmcnt(0)
    v_cmp_ne_u64 vcc, s[60:61], v[18:19]
    v_cmp_ne_u64 s[56:57], s[60:61], v[22:23]
    s_or_b64 vcc, vcc, s[56:57]
    v_cmp_ne_u64 s[56:57], s[60:61], v[26:27]
    s_or_b64 vcc, vcc, s[56:57]
    v_cmp_ne_u64 s[56:57], s[60:61], v[30:31]
    s_or_b64 vcc, vcc, s[56:57]
    s_cbranch_vccz L_pd_65
    s_add_u32 s59, s59, 1
    s_cmp_lt_u32 s59, 65536
    s_cbranch_scc1 L_po_64
    s_mov_b32 s57, 12
    s_branch L_abort
L_pd_65:
    v_mul_f32 v16, v16, v146
    v_mul_f32 v17, v17, v146
    v_mul_f32 v24, v24, v148
    v_mul_f32 v25, v25, v148
    v_fmac_f32 v16, v20, v147
    v_fmac_f32 v17, v21, v147
    v_fmac_f32 v24, v28, v149
    v_fmac_f32 v25, v29, v149
    v_add_f32 v16, v16, v24
    v_add_f32 v17, v17, v25
    v_mov_b32 v18, v16
    v_mov_b32 v19, v17
    s_nop 1
    v_permlane32_swap_b32 v16, v18
    v_permlane32_swap_b32 v17, v19
    s_nop 1
    v_add_f32 v16, v16, v18
    v_add_f32 v17, v17, v19
    v_cvt_pk_bf16_f32 v16, v16, v16
    v_cvt_pk_bf16_f32 v17, v17, v17
    s_mov_b32 exec_hi, 0
    ds_write_b32 v49, v16
    ds_write_b32 v49, v17 offset:64
    s_mov_b32 exec_hi, -1
    s_waitcnt lgkmcnt(0)
    ds_read_b128 v[16:19], v50
    ds_read_b128 v[20:23], v50 offset:16
    ds_read_b128 v[24:27], v50 offset:32
    ds_read_b128 v[28:31], v50 offset:48
    s_waitcnt lgkmcnt(0)
    v_and_b32 v32, v16, v8
    v_and_b32 v33, v16, v9
    v_and_b32 v34, v16, v10
    v_and_b32 v35, v16, v11
    v_and_b32 v36, v17, v8
    v_and_b32 v37, v17, v9
    v_and_b32 v38, v17, v10
    v_and_b32 v39, v17, v11
    v_mfma_f32_16x16x32_bf16 v[40:43], v[32:35], v[64:67], 0
    v_and_b32 v32, v18, v8
    v_and_b32 v33, v18, v9
    v_and_b32 v34, v18, v10
    v_and_b32 v35, v18, v11
    v_mfma_f32_16x16x32_bf16 v[40:43], v[36:39], v[68:71], v[40:43]
    v_and_b32 v36, v19, v8
    v_and_b32 v37, v19, v9
    v_and_b32 v38, v19, v10
    v_and_b32 v39, v19, v11
    v_mfma_f32_16x16x32_bf16 v[40:43], v[32:35], v[72:75], v[40:43]
    v_and_b32 v32, v20, v8
    v_and_b32 v33, v20, v9
    v_and_b32 v34, v20, v10
    v_and_b32 v35, v20, v11
    v_mfma_f32_16x16x32_bf16 v[40:43], v[36:39], v[76:79], v[40:43]
    v_and_b32 v36, v21, v8
    v_and_b32 v37, v21, v9
    v_and_b32 v38, v21, v10
    v_and_b32 v39, v21, v11
    v_mfma_f32_16x16x32_bf16 v[40:43], v[32:35], v[80:83], v[40:43]
    v_and_b32 v32, v22, v8
    v_and_b32 v33, v22, v9
    v_and_b32 v34, v22, v10
    v_and_b32 v35, v22, v11
    v_mfma_f32_16x16x32_bf16 v[40:43], v[36:39], v[84:87], v[40:43]
    v_and_b32 v36, v23, v8
    v_and_b32 v37, v23, v9
    v_and_b32 v38, v23, v10
    v_and_b32 v39, v23, v11
    v_mfma_f32_16x16x32_bf16 v[40:43], v[32:35], v[88:91], v[40:43]
    v_and_b32 v32, v24, v8
    v_and_b32 v33, v24, v9
    v_and_b32 v34, v24, v10
    v_and_b32 v35, v24, v11
    v_mfma_f32_16x16x32_bf16 v[40:43], v[36:39], v[92:95], v[40:43]
    v_and_b32 v36, v25, v8
    v_and_b32 v37, v25, v9
    v_and_b32 v38, v25, v10
    v_and_b32 v39, v25, v11
    v_mfma_f32_16x16x32_bf16 v[40:43], v[32:35], v[96:99], v[40:43]
    v_and_b32 v32, v26, v8
    v_and_b32 v33, v26, v9
    v_and_b32 v34, v26, v10
    v_and_b32 v35, v26, v11
    v_mfma_f32_16x16x32_bf16 v[40:43], v[36:39], v[100:103], v[40:43]
    v_and_b32 v36, v27, v8
    v_and_b32 v37, v27, v9
    v_and_b32 v38, v27, v10
    v_and_b32 v39, v27, v11
    v_mfma_f32_16x16x32_bf16 v[40:43], v[32:35], v[104:107], v[40:43]
    v_and_b32 v32, v28, v8
    v_and_b32 v33, v28, v9
    v_and_b32 v34, v28, v10
    v_and_b32 v35, v28, v11
    v_mfma_f32_16x16x32_bf16 v[40:43], v[36:39], v[108:111], v[40:43]
    v_and_b32 v36, v29, v8
    v_and_b32 v37, v29, v9
    v_and_b32 v38, v29, v10
    v_and_b32 v39, v29, v11
    v_mfma_f32_16x16x32_bf16 v[40:43], v[32:35], v[112:115], v[40:43]
    v_and_b32 v32, v30, v8
    v_and_b32 v33, v30, v9
    v_and_b32 v34, v30, v10
    v_and_b32 v35, v30, v11
    v_mfma_f32_16x16x32_bf16 v[40:43], v[36:39], v[116:119], v[40:43]
    v_and_b32 v36, v31, v8
    v_and_b32 v37, v31, v9
    v_and_b32 v38, v31, v10
    v_and_b32 v39, v31, v11
    v_mfma_f32_16x16x32_bf16 v[40:43], v[32:35], v[120:123], v[40:43]
    s_nop 1
    v_mfma_f32_16x16x32_bf16 v[40:43], v[36:39], v[124:127], v[40:43]
    s_nop 7
    v_cndmask_b32 v52, v40, v42, s[50:51]
    v_cndmask_b32 v53, v41, v43, s[50:51]
    buffer_store_dwordx4 v[52:55], v51, s[36:39], s49 offen sc1
    s_endpgm
L_abort:
    s_mov_b32 s40, s24
    s_mov_b32 s41, s25
    s_mov_b32 s42, 256
    s_mov_b32 s43, 0x20000
    s_mov_b64 exec, 1
    v_mov_b32 v2, s57
    v_mov_b32 v3, s2
    v_mov_b32 v4, 0
    buffer_store_dwordx2 v[2:3], v4, s[40:43], 0 offen
L_end:
    s_endpgm
L_codeend:
    .fill (16896 - (L_codeend - recurrent_scan__sliding_block_cached__glu_gated_reglu__decode_kernel))/4, 4, 0xbf810000
.section .rodata,"a"
.p2align 6
.amdhsa_kernel recurrent_scan__sliding_block_cached__glu_gated_reglu__decode_kernel
  .amdhsa_next_free_vgpr 240
  .amdhsa_next_free_sgpr 100
  .amdhsa_accum_offset 240
  .amdhsa_group_segment_fixed_size 0
  .amdhsa_kernarg_size 96
  .amdhsa_user_sgpr_count 2
  .amdhsa_user_sgpr_kernarg_segment_ptr 1
  .amdhsa_system_sgpr_workgroup_id_x 1
.end_amdhsa_kernel
```
